```python
import torch

def _softmax(x, axis=-1):
    return torch.softmax(x, dim=axis)
def _gelu(x):
    return torch.nn.functional.gelu(x, approximate="tanh")
def _silu(x):
    return torch.nn.functional.silu(x)
def _sigmoid(x):
    return torch.sigmoid(x)
def _layernorm(x, axis=-1, eps=1e-5):
    m = x.mean(dim=axis, keepdim=True)
    v = x.var(dim=axis, keepdim=True, unbiased=False)
    return (x - m) / torch.sqrt(v + eps)
def _scatter_add(tgt, idx, src, axis=0):
    return tgt.clone().index_add_(axis, idx, src)
def _segment_sum(src, seg, n):
    out = torch.zeros((n,) + src.shape[1:], dtype=src.dtype)
    return out.index_add_(0, seg, src)
def _pad(x, pw):
    flat = tuple(v for pair in reversed(pw) for v in pair)
    return torch.nn.functional.pad(x, flat)

kernel_name = 'gather_scatter__edge_featured_mpnn_egc__graph'

def setup_inputs():

    _w = (lambda a: (lambda t: t.to(torch.bfloat16) if t.is_floating_point() else t)(torch.as_tensor(a)))
    N, deg, D, De = 10000, 16, 128, max(0, 1)
    E = N * deg
    return {
        "x": _w((lambda *s: torch.randn(*s, dtype=torch.bfloat16) * 0.1)(N, D)),
        "e_attr": _w((lambda *s: torch.randn(*s, dtype=torch.bfloat16) * 0.1)(E, De)),
        "src": _w((lambda lo, hi, *s: torch.randint(lo, hi, s))(0, N, E).to(torch.int64)),
        "dst": _w((lambda lo, hi, *s: torch.randint(lo, hi, s))(0, N, E).to(torch.int64)),
        "u_w": _w((lambda *s: torch.randn(*s, dtype=torch.bfloat16) * 0.05)(D, D)),
        "v_w": _w((lambda *s: torch.randn(*s, dtype=torch.bfloat16) * 0.05)(D, D)),
        "g_w": _w((lambda *s: torch.randn(*s, dtype=torch.bfloat16) * 0.1)(2 * D + De, D)),
    }

def reference(x, e_attr, src, dst, u_w, v_w, g_w):
    N, D = x.shape
    g_in = torch.concatenate([x[dst], x[src], e_attr], axis=-1)
    eta = _sigmoid(g_in @ g_w)
    hv = x @ v_w
    msg = eta * hv[src]
    agg = _segment_sum(msg, dst, N)
    return _silu(x @ u_w + agg)
```

```asm
; @launch grid=(256,1,1) block=(1024,1,1) lds=163840
.amdgcn_target "amdgcn-amd-amdhsa--gfx950"
.text
.globl gather_scatter__edge_featured_mpnn_egc__graph_kernel
.type gather_scatter__edge_featured_mpnn_egc__graph_kernel,@function
.p2align 8
gather_scatter__edge_featured_mpnn_egc__graph_kernel:
    s_load_dwordx16 s[4:19], s[0:1], 0
    s_load_dwordx2 s[20:21], s[0:1], 72
    s_getpc_b64 s[46:47]
L_pc:
    v_lshlrev_b32 v3, 7, v0
    v_min_u32 v3, L_code_end-L_pc-128, v3
    global_load_dword v40, v3, s[46:47] offset:128
    v_lshrrev_b32 v1, 6, v0
    s_cmp_ge_u32 s2, 256
    s_cbranch_scc1 L_end
    v_readfirstlane_b32 s32, v1
    v_lshlrev_b32 v2, 4, v0
    s_and_b32 s44, s2, 7
    s_lshr_b32 s36, s2, 5
    s_lshl3_add_u32 s36, s44, s36
    s_mov_b32 s3, 7602176
    s_lshr_b32 s33, s2, 3
    s_bfe_u32 s34, s2, 0x10002
    s_and_b32 s35, s2, 3
    s_lshl_b32 s35, s35, 5
    s_add_u32 s35, s35, s33
    s_lshl_b32 s42, s34, 7
    s_lshl_b32 s43, s35, 8
    s_cmp_ge_u32 s32, 12
    s_cbranch_scc1 L_dmawave
    v_mov_b64 v[8:9], -1
    v_mov_b64 v[10:11], -1
    v_add_u32 v12, 88064, v2
    ds_write_b128 v12, v[8:11]
    s_cmp_ge_u32 s32, 10
    s_cbranch_scc1 L_initwave
    s_mul_i32 s45, s36, 10000
    v_add_u32 v2, s45, v2
    v_cmp_gt_u32 vcc, 625, v0
    v_lshrrev_b32 v3, 1, v2
    s_mov_b64 exec, vcc
    s_waitcnt lgkmcnt(0)
    global_load_dwordx4 v[8:11], v2, s[10:11]
    s_load_dword s38, s[20:21], s3
    global_load_dwordx4 v[12:15], v2, s[8:9]
    global_load_dwordx2 v[16:17], v3, s[6:7]
L_warmed:
    s_barrier
    s_branch L_edge2
L_dmawave:
    s_setprio 3
    s_load_dwordx2 s[66:67], s[0:1], 64
    v_and_b32 v3, 255, v0
    v_lshrrev_b32 v5, 3, v3
    v_lshrrev_b32 v6, 4, v3
    v_and_b32 v4, 2, v5
    v_and_or_b32 v4, v6, 4, v4
    v_xor_b32 v4, v4, v0
    v_and_b32 v4, 7, v4
    v_lshl_or_b32 v4, v4, 4, s42
    v_lshl_or_b32 v28, v5, 8, v4
    v_xor_b32 v5, v6, v0
    v_and_b32 v5, 15, v5
    v_lshl_or_b32 v5, v5, 4, s43
    v_lshl_or_b32 v16, v6, 15, v5
    s_lshl_b32 s50, s32, 10
    s_waitcnt lgkmcnt(0)
    s_load_dword s38, s[20:21], s3
    s_barrier
    s_add_u32 m0, s50, 0xd800
    v_add_u32 v17, 0, v16
    global_load_lds_dwordx4 v17, s[4:5]
    s_add_u32 m0, s50, 0x5800
    v_add_u32 v17, 32768, v28
    global_load_lds_dwordx4 v17, s[16:17]
    s_add_u32 m0, s50, 0x9800
    v_add_u32 v17, 0, v28
    global_load_lds_dwordx4 v17, s[14:15]
    s_add_u32 m0, s50, 0xe800
    v_add_u32 v17, 524288, v16
    global_load_lds_dwordx4 v17, s[4:5]
    s_add_u32 m0, s50, 0x6800
    v_add_u32 v17, 40960, v28
    global_load_lds_dwordx4 v17, s[16:17]
    s_add_u32 m0, s50, 0xa800
    v_add_u32 v17, 8192, v28
    global_load_lds_dwordx4 v17, s[14:15]
    s_add_u32 m0, s50, 0xf800
    v_add_u32 v17, 1048576, v16
    global_load_lds_dwordx4 v17, s[4:5]
    s_add_u32 m0, s50, 0x7800
    v_add_u32 v17, 49152, v28
    global_load_lds_dwordx4 v17, s[16:17]
    s_add_u32 m0, s50, 0xb800
    v_add_u32 v17, 16384, v28
    global_load_lds_dwordx4 v17, s[14:15]
    s_add_u32 m0, s50, 0x10800
    v_add_u32 v17, 1572864, v16
    global_load_lds_dwordx4 v17, s[4:5]
    s_add_u32 m0, s50, 0x8800
    v_add_u32 v17, 57344, v28
    global_load_lds_dwordx4 v17, s[16:17]
    s_add_u32 m0, s50, 0xc800
    v_add_u32 v17, 24576, v28
    global_load_lds_dwordx4 v17, s[14:15]
    s_add_u32 m0, s50, 0x11800
    v_add_u32 v17, 2097152, v16
    v_min_u32 v17, 2559984, v17
    global_load_lds_dwordx4 v17, s[4:5]
    s_mov_b32 s22, 37748736
    s_mov_b32 s23, 0x20000
    s_mov_b32 s40, 0xbfb8aa3b
    s_mov_b32 s41, 0xbfb8aa3b
    s_and_b32 s37, s33, 3
    s_mov_b32 s52, 16777216
    s_and_b32 s71, s43, 0x6000
    s_add_u32 s71, s71, s43
    v_and_b32 v1, 63, v0
    v_and_b32 v2, 15, v0
    v_subrev_u32 v3, 512, v0
    v_mul_u32_u24 v4, 171, v3
    v_lshrrev_b32 v4, 12, v4
    v_mul_u32_u24 v26, 24, v4
    v_sub_u32 v26, v3, v26
    v_mul_u32_u24 v5, 784, v4
    v_add_u32 v5, 88064, v5
    v_lshrrev_b32 v6, 3, v26
    v_and_b32 v7, 7, v26
    v_cmp_eq_u32 vcc, 1, v6
    v_mul_u32_u24 v6, 196, v6
    v_lshl_add_u32 v6, v7, 3, v6
    v_mad_i32_i24 v25, v7, -8, v5
    v_add_u32 v25, 640, v25
    v_add_u32 v5, v5, v6
    v_subrev_u32 v6, 4, v5
    v_cndmask_b32 v5, v5, v6, vcc
    v_mov_b32 v6, 1792
    v_cndmask_b32 v25, v6, v25, vcc
    s_movk_i32 s45, 24192
    v_lshlrev_b32 v24, 4, v3
    v_mad_u32_u24 v24, v4, s45, v24
    v_lshlrev_b32 v7, 3, v2
    v_add_u32 v7, 163328, v7
    v_mul_u32_u24 v6, 784, v2
    v_add_u32 v6, 88448, v6
    v_add_u32 v27, 392, v6
    v_add_u32 v4, v6, v27
    v_subrev_u32 v4, 192, v4
    s_mov_b32 s72, 0x0c0c0400
    s_mov_b32 s73, 0x04000c0c
    s_mul_i32 s56, s37, 393216
    s_mul_i32 s45, s36, 384
    s_add_u32 s56, s56, s45
    s_add_u32 s56, s56, 5242880
    s_add_u32 m0, s50, 0xffffd800
    v_add_u32 v17, 0, v28
    global_load_lds_dwordx4 v17, s[16:17]
    s_add_u32 m0, s50, 0x1800
    v_add_u32 v17, 0, v28
    global_load_lds_dwordx4 v17, s[12:13]
    s_add_u32 m0, s50, 0xffffe800
    v_add_u32 v17, 8192, v28
    global_load_lds_dwordx4 v17, s[16:17]
    s_add_u32 m0, s50, 0x2800
    v_add_u32 v17, 8192, v28
    global_load_lds_dwordx4 v17, s[12:13]
    s_add_u32 m0, s50, 0xfffff800
    v_add_u32 v17, 16384, v28
    global_load_lds_dwordx4 v17, s[16:17]
    s_add_u32 m0, s50, 0x3800
    v_add_u32 v17, 16384, v28
    global_load_lds_dwordx4 v17, s[12:13]
    s_add_u32 m0, s50, 0x800
    v_add_u32 v17, 24576, v28
    global_load_lds_dwordx4 v17, s[16:17]
    s_add_u32 m0, s50, 0x4800
    v_add_u32 v17, 24576, v28
    global_load_lds_dwordx4 v17, s[12:13]
    s_branch L_rb1
L_edge2:
    s_mov_b64 exec, -1
    s_mov_b64 s[60:61], vcc
    s_mov_b32 s22, 37748736
    s_mov_b32 s23, 0x20000
    s_mov_b32 s40, 0xbfb8aa3b
    s_mov_b32 s41, 0xbfb8aa3b
    s_and_b32 s37, s33, 3
    s_mov_b32 s52, 16777216
    s_and_b32 s71, s43, 0x6000
    s_add_u32 s71, s71, s43
    v_and_b32 v1, 63, v0
    v_and_b32 v2, 15, v0
    s_mov_b64 s[66:67], s[20:21]
    s_cmp_lt_u32 s32, 8
    s_cbranch_scc1 L_gset
    v_mov_b32 v113, 0
    v_subrev_u32 v3, 512, v0
    v_mul_u32_u24 v4, 171, v3
    v_lshrrev_b32 v4, 12, v4
    v_mul_u32_u24 v26, 24, v4
    v_sub_u32 v26, v3, v26
    v_mul_u32_u24 v5, 784, v4
    v_add_u32 v5, 88064, v5
    v_lshrrev_b32 v6, 3, v26
    v_and_b32 v7, 7, v26
    v_cmp_eq_u32 vcc, 1, v6
    v_mul_u32_u24 v6, 196, v6
    v_lshl_add_u32 v6, v7, 3, v6
    v_mad_i32_i24 v25, v7, -8, v5
    v_add_u32 v25, 640, v25
    v_add_u32 v5, v5, v6
    v_subrev_u32 v6, 4, v5
    v_cndmask_b32 v5, v5, v6, vcc
    v_mov_b32 v6, 1792
    v_cndmask_b32 v25, v6, v25, vcc
    s_movk_i32 s45, 24192
    v_lshlrev_b32 v24, 4, v3
    v_mad_u32_u24 v24, v4, s45, v24
    v_lshlrev_b32 v7, 3, v2
    v_add_u32 v7, 163328, v7
    v_mul_u32_u24 v6, 784, v2
    v_add_u32 v6, 88448, v6
    v_add_u32 v27, 392, v6
    v_add_u32 v4, v6, v27
    v_subrev_u32 v4, 192, v4
    s_mov_b32 s72, 0x0c0c0400
    s_mov_b32 s73, 0x04000c0c
    s_mul_i32 s56, s37, 393216
    s_mul_i32 s45, s36, 384
    s_add_u32 s56, s56, s45
    s_add_u32 s56, s56, 5242880
    s_branch L_bin
L_gset:
    v_mov_b32 v24, 0
    s_lshr_b32 s44, s32, 2
    s_mul_i32 s44, s44, 3
    s_and_b32 s45, s32, 3
    s_lshl_b32 s46, s44, 12
    s_add_u32 s46, s46, 67584
    v_lshrrev_b32 v3, 4, v1
    v_xor_b32 v4, v2, v3
    v_lshlrev_b32 v4, 4, v4
    v_lshl_or_b32 v4, v2, 8, v4
    v_add_u32 v4, s46, v4
    v_xor_b32 v5, 64, v4
    v_xor_b32 v6, 128, v4
    v_xor_b32 v7, 192, v4
    v_bfe_u32 v113, v1, 3, 2
    v_xor_b32 v113, s45, v113
    v_and_b32 v112, 3, v1
    v_lshlrev_b32 v112, 3, v112
    v_lshl_or_b32 v112, v113, 5, v112
    v_bfe_u32 v113, v1, 2, 2
    v_lshl_or_b32 v112, v113, 7, v112
    v_lshl_or_b32 v112, v3, 10, v112
    v_add_u32 v112, 2048, v112
    v_lshlrev_b32 v3, 4, v3
    s_lshl_b32 s45, s45, 6
    s_mul_i32 s46, s44, 8448
    s_add_u32 s46, s46, s45
    s_add_u32 s46, s46, 34816
    v_mul_u32_u24 v114, 528, v2
    v_add3_u32 v114, v114, v3, s46
    s_lshr_b32 s44, s32, 2
    s_mul_i32 s44, s44, 5242880
    s_add_u32 s53, s52, s71
    s_add_u32 s53, s53, s45
    s_add_u32 s53, s53, s44
    v_lshlrev_b32 v124, 3, v2
    v_xor_b32 v3, v3, v124
    v_and_b32 v3, 48, v3
    v_lshl_or_b32 v3, v2, 6, v3
    s_lshl_b32 s44, s32, 10
    s_add_u32 s44, s44, 133376
    v_add_u32 v3, s44, v3
    v_lshrrev_b32 v124, 3, v1
    v_xor_b32 v124, v124, v1
    v_and_b32 v124, 3, v124
    v_lshlrev_b32 v124, 4, v124
    v_lshrrev_b32 v113, 2, v1
    v_lshl_or_b32 v113, v113, 16, v124
    v_lshl_add_u32 v124, v1, 4, s44
L_bin:
    s_mul_i32 s44, s37, -128
    s_movk_i32 s45, 0x1fc
    s_mov_b32 s46, 0xffff0000
    v_mov_b32 v18, 8
    v_mov_b32 v19, 163328
    s_mov_b64 exec, s[60:61]
    s_setprio 1
    s_waitcnt vmcnt(2)
    v_lshl_add_u32 v20, v8, 2, s44
    v_and_or_b32 v20, v20, s45, v19
    ds_add_rtn_u32 v20, v20, v18 offset:384
    v_lshl_add_u32 v21, v9, 2, s44
    v_and_or_b32 v21, v21, s45, v19
    ds_add_rtn_u32 v21, v21, v18 offset:384
    v_lshl_add_u32 v22, v10, 2, s44
    v_and_or_b32 v22, v22, s45, v19
    ds_add_rtn_u32 v22, v22, v18 offset:384
    v_lshl_add_u32 v23, v11, 2, s44
    v_and_or_b32 v23, v23, s45, v19
    ds_add_rtn_u32 v23, v23, v18 offset:384
    v_lshrrev_b32 v19, 7, v8
    v_lshl_or_b32 v8, v8, 7, v19
    v_lshrrev_b32 v19, 7, v9
    v_lshl_or_b32 v9, v9, 7, v19
    v_lshrrev_b32 v19, 7, v10
    v_lshl_or_b32 v10, v10, 7, v19
    v_lshrrev_b32 v19, 7, v11
    v_lshl_or_b32 v11, v11, 7, v19
    s_waitcnt vmcnt(1)
    v_and_b32 v19, 0xffffffe0, v12
    v_add_u32 v12, v12, v19
    v_and_b32 v19, 0xffffe000, v12
    v_add_u32 v12, v12, v19
    v_and_b32 v19, 0xffffffe0, v13
    v_add_u32 v13, v13, v19
    v_and_b32 v19, 0xffffe000, v13
    v_add_u32 v13, v13, v19
    v_and_b32 v19, 0xffffffe0, v14
    v_add_u32 v14, v14, v19
    v_and_b32 v19, 0xffffe000, v14
    v_add_u32 v14, v14, v19
    v_and_b32 v19, 0xffffffe0, v15
    v_add_u32 v15, v15, v19
    v_and_b32 v19, 0xffffe000, v15
    v_add_u32 v15, v15, v19
    s_waitcnt vmcnt(0)
    v_lshl_or_b32 v12, v16, 16, v12
    v_and_or_b32 v13, v16, s46, v13
    v_lshl_or_b32 v14, v17, 16, v14
    v_and_or_b32 v15, v17, s46, v15
    s_waitcnt lgkmcnt(0)
    ds_write2_b32 v20, v12, v8 offset0:0 offset1:1
    ds_write2_b32 v21, v13, v9 offset0:0 offset1:1
    ds_write2_b32 v22, v14, v10 offset0:0 offset1:1
    ds_write2_b32 v23, v15, v11 offset0:0 offset1:1
    s_setprio 0
    s_mov_b64 exec, -1
    s_cmp_ge_u32 s32, 8
    s_cbranch_scc1 L_rb1
    s_and_b32 s51, s35, 1
    s_mul_i32 s74, s51, 296
    v_lshlrev_b32 v127, 3, v2
    v_lshrrev_b32 v127, v127, s38
    v_mad_u32_u24 v127, v2, 37, v127
    v_add_u32 v127, s74, v127
    s_add_u32 s38, s38, 0x01010101
    s_lshr_b32 s74, s35, 1
    s_mul_i32 s74, s74, 192
    s_add_u32 s74, s74, s51
    s_lshl_b32 s74, s74, 7
    v_and_b32 v127, 0xff, v127
    s_add_u32 s74, s74, 5242880
    s_mul_i32 s51, s51, 0x808080
    v_and_b32 v24, 1, v1
    v_lshlrev_b32 v24, 4, v24
    v_mov_b32 v25, 0x3f80
    v_lshlrev_b32 v25, v24, v25
    v_and_b32 v24, 2, v1
    v_cmp_eq_u32 vcc, 0, v24
    v_lshlrev_b32 v119, 4, v2
    v_lshrrev_b32 v115, 4, v1
    v_cndmask_b32 v116, 0, v25, vcc
    v_sub_u32 v117, v25, v116
    v_lshlrev_b32 v115, 2, v115
    v_mov_b32 v121, v119
    v_and_b32 v125, 12, v1
    v_cmp_eq_u32 vcc, v125, v115
    v_and_b32 v24, 3, v1
    v_lshlrev_b32 v24, 2, v24
    v_cndmask_b32 v122, 0, v116, vcc
    v_cndmask_b32 v123, 0, v117, vcc
    v_cmp_ne_u32 vcc, v24, v115
    v_mov_b32 v25, 0x100000
    s_mov_b32 s76, 16
    s_mov_b32 s77, 16
    v_cndmask_b32 v126, 0, v25, vcc
    s_mov_b32 s46, 0x45673210
    s_mov_b32 s47, 0xcdefa98b
    s_lshl_b32 s54, s32, 2
    s_lshr_b64 s[46:47], s[46:47], s54
    s_and_b32 s54, s46, 15
    s_add_u32 s57, s43, s42
    s_add_u32 s24, s20, s52
    s_addc_u32 s25, s21, 0x1000000
    s_mov_b32 s26, 36864
    s_mov_b32 s27, 0x20000
    s_mov_b64 s[28:29], s[18:19]
    s_mov_b32 s30, 2560000
    s_mov_b32 s31, 0x20000
    s_mov_b64 s[58:59], 0
    s_mov_b32 s68, 0
    s_waitcnt lgkmcnt(0)
    s_cmp_ge_u32 s32, 4
    s_barrier
    ds_read_b64_tr_b16 v[8:9], v112 offset:32768
    ds_read_b64_tr_b16 v[10:11], v112 offset:33280
    ds_read_b64_tr_b16 v[24:25], v112 offset:49152
    ds_read_b64_tr_b16 v[26:27], v112 offset:49664
    ds_read_b128 v[40:43], v4 offset:0
    ds_read_b64_tr_b16 v[12:13], v112 offset:36864
    ds_read_b64_tr_b16 v[14:15], v112 offset:37376
    ds_read_b64_tr_b16 v[28:29], v112 offset:53248
    ds_read_b64_tr_b16 v[30:31], v112 offset:53760
    ds_read_b128 v[44:47], v5 offset:0
    ds_read_b64_tr_b16 v[16:17], v112 offset:40960
    ds_read_b64_tr_b16 v[18:19], v112 offset:41472
    ds_read_b64_tr_b16 v[32:33], v112 offset:57344
    ds_read_b64_tr_b16 v[34:35], v112 offset:57856
    ds_read_b128 v[48:51], v6 offset:0
    s_waitcnt lgkmcnt(10)
    ds_read_b64_tr_b16 v[20:21], v112 offset:45056
    ds_read_b64_tr_b16 v[22:23], v112 offset:45568
    ds_read_b64_tr_b16 v[36:37], v112 offset:61440
    ds_read_b64_tr_b16 v[38:39], v112 offset:61952
    ds_read_b128 v[52:55], v7 offset:0
    s_waitcnt lgkmcnt(10)
    ds_read_b128 v[56:59], v4 offset:4096
    ds_read_b128 v[60:63], v5 offset:4096
    ds_read_b128 v[64:67], v6 offset:4096
    ds_read_b128 v[68:71], v7 offset:4096
    v_mfma_f32_16x16x32_bf16 v[88:91], v[8:11], v[40:43], 0
    v_mfma_f32_16x16x32_bf16 v[92:95], v[24:27], v[40:43], 0
    v_mfma_f32_16x16x32_bf16 v[88:91], v[12:15], v[44:47], v[88:91]
    v_mfma_f32_16x16x32_bf16 v[92:95], v[28:31], v[44:47], v[92:95]
    s_waitcnt lgkmcnt(9)
    v_mfma_f32_16x16x32_bf16 v[88:91], v[16:19], v[48:51], v[88:91]
    v_mfma_f32_16x16x32_bf16 v[92:95], v[32:35], v[48:51], v[92:95]
    s_waitcnt lgkmcnt(4)
    v_mfma_f32_16x16x32_bf16 v[88:91], v[20:23], v[52:55], v[88:91]
    v_mfma_f32_16x16x32_bf16 v[92:95], v[36:39], v[52:55], v[92:95]
    s_waitcnt lgkmcnt(0)
    s_cbranch_scc1 L_nox2
    ds_read_b128 v[72:75], v4 offset:8192
    ds_read_b128 v[76:79], v5 offset:8192
    ds_read_b128 v[80:83], v6 offset:8192
    ds_read_b128 v[84:87], v7 offset:8192
L_nox2:
    v_mov_b32 v2, 0
    v_mfma_f32_16x16x32_bf16 v[96:99], v[8:11], v[56:59], 0
    v_mfma_f32_16x16x32_bf16 v[100:103], v[24:27], v[56:59], 0
    s_nop 1
    v_mul_f32 v88, s40, v88
    v_mul_f32 v89, s40, v89
    v_mul_f32 v90, s40, v90
    v_mul_f32 v91, s40, v91
    v_mfma_f32_16x16x32_bf16 v[96:99], v[12:15], v[60:63], v[96:99]
    v_cvt_pk_bf16_f32 v88, v88, v89
    v_cvt_pk_bf16_f32 v89, v90, v91
    v_cvt_pk_bf16_f32 v90, v92, v93
    v_cvt_pk_bf16_f32 v91, v94, v95
    ds_read_b32 v2, v2 offset:1284
    ds_write_b128 v3, v[88:91]
    ds_read_b128 v[92:95], v124
    v_mfma_f32_16x16x32_bf16 v[100:103], v[28:31], v[60:63], v[100:103]
    v_mfma_f32_16x16x32_bf16 v[96:99], v[16:19], v[64:67], v[96:99]
    v_mfma_f32_16x16x32_bf16 v[100:103], v[32:35], v[64:67], v[100:103]
    s_waitcnt lgkmcnt(2)
    v_cmp_eq_u32 vcc, 0, v2
    s_cbranch_vccnz L_selwait
L_selgot:
    v_add3_u32 v113, v113, v2, -1
    v_mfma_f32_16x16x32_bf16 v[96:99], v[20:23], v[68:71], v[96:99]
    v_mfma_f32_16x16x32_bf16 v[100:103], v[36:39], v[68:71], v[100:103]
    s_waitcnt lgkmcnt(0)
    buffer_store_dwordx4 v[92:95], v113, s[20:23], s53 offen sc1
    s_cbranch_scc1 L_two_g1
    s_add_u32 s53, s53, 1048576
    v_mfma_f32_16x16x32_bf16 v[104:107], v[8:11], v[72:75], 0
    v_mfma_f32_16x16x32_bf16 v[108:111], v[24:27], v[72:75], 0
    s_nop 0
    v_mul_f32 v96, s40, v96
    v_mul_f32 v97, s40, v97
    v_mul_f32 v98, s40, v98
    v_mul_f32 v99, s40, v99
    v_mfma_f32_16x16x32_bf16 v[104:107], v[12:15], v[76:79], v[104:107]
    v_cvt_pk_bf16_f32 v96, v96, v97
    v_cvt_pk_bf16_f32 v97, v98, v99
    v_cvt_pk_bf16_f32 v98, v100, v101
    v_cvt_pk_bf16_f32 v99, v102, v103
    ds_write_b128 v3, v[96:99]
    ds_read_b128 v[100:103], v124
    v_mfma_f32_16x16x32_bf16 v[108:111], v[28:31], v[76:79], v[108:111]
    v_mfma_f32_16x16x32_bf16 v[104:107], v[16:19], v[80:83], v[104:107]
    v_mfma_f32_16x16x32_bf16 v[108:111], v[32:35], v[80:83], v[108:111]
    v_mfma_f32_16x16x32_bf16 v[104:107], v[20:23], v[84:87], v[104:107]
    v_mfma_f32_16x16x32_bf16 v[108:111], v[36:39], v[84:87], v[108:111]
    s_waitcnt lgkmcnt(0)
    buffer_store_dwordx4 v[100:103], v113, s[20:23], s53 offen sc1
    s_add_u32 s53, s53, 3145728
    s_nop 3
    v_mul_f32 v104, s40, v104
    v_mul_f32 v105, s40, v105
    v_mul_f32 v106, s40, v106
    v_mul_f32 v107, s40, v107
    v_cvt_pk_bf16_f32 v104, v104, v105
    v_cvt_pk_bf16_f32 v105, v106, v107
    v_cvt_pk_bf16_f32 v106, v108, v109
    v_cvt_pk_bf16_f32 v107, v110, v111
    ds_write_b128 v3, v[104:107]
    ds_read_b128 v[108:111], v124
    s_waitcnt lgkmcnt(0)
    buffer_store_dwordx4 v[108:111], v113, s[20:23], s53 offen sc1
    s_branch L_bm
L_two_g1:
    s_add_u32 s53, s53, 3145728
    s_setprio 1
    s_nop 1
    v_mul_f32 v96, s40, v96
    v_mul_f32 v97, s40, v97
    v_mul_f32 v98, s40, v98
    v_mul_f32 v99, s40, v99
    v_cvt_pk_bf16_f32 v96, v96, v97
    v_cvt_pk_bf16_f32 v97, v98, v99
    v_cvt_pk_bf16_f32 v98, v100, v101
    v_cvt_pk_bf16_f32 v99, v102, v103
    ds_write_b128 v3, v[96:99]
    ds_read_b128 v[100:103], v124
    s_waitcnt lgkmcnt(0)
    buffer_store_dwordx4 v[100:103], v113, s[20:23], s53 offen sc1
    s_setprio 0
L_bm:
    s_barrier
    ds_read_b64_tr_b16 v[8:9], v112 offset:0
    ds_read_b64_tr_b16 v[10:11], v112 offset:512
    ds_read_b64_tr_b16 v[24:25], v112 offset:16384
    ds_read_b64_tr_b16 v[26:27], v112 offset:16896
    ds_read_b64_tr_b16 v[12:13], v112 offset:4096
    ds_read_b64_tr_b16 v[14:15], v112 offset:4608
    ds_read_b64_tr_b16 v[28:29], v112 offset:20480
    ds_read_b64_tr_b16 v[30:31], v112 offset:20992
    ds_read_b64_tr_b16 v[16:17], v112 offset:8192
    ds_read_b64_tr_b16 v[18:19], v112 offset:8704
    ds_read_b64_tr_b16 v[32:33], v112 offset:24576
    ds_read_b64_tr_b16 v[34:35], v112 offset:25088
    s_cmp_lt_u32 s32, 4
    s_cbranch_scc1 L_g2go
    v_and_b32 v113, 0x3f0, v0
    v_lshlrev_b32 v113, 3, v113
    v_lshl_add_u32 v113, v0, 4, v113
    s_waitcnt vmcnt(0)
    s_barrier
    buffer_load_dwordx4 v[4:7], v113, s[20:23], s74 offen sc1
L_g2go:
    s_waitcnt lgkmcnt(8)
    v_mfma_f32_16x16x32_bf16 v[88:91], v[8:11], v[40:43], 0
    v_mfma_f32_16x16x32_bf16 v[92:95], v[24:27], v[40:43], 0
    ds_read_b64_tr_b16 v[20:21], v112 offset:12288
    ds_read_b64_tr_b16 v[22:23], v112 offset:12800
    ds_read_b64_tr_b16 v[36:37], v112 offset:28672
    ds_read_b64_tr_b16 v[38:39], v112 offset:29184
    s_waitcnt lgkmcnt(8)
    v_mfma_f32_16x16x32_bf16 v[88:91], v[12:15], v[44:47], v[88:91]
    v_mfma_f32_16x16x32_bf16 v[92:95], v[28:31], v[44:47], v[92:95]
    s_waitcnt lgkmcnt(4)
    v_mfma_f32_16x16x32_bf16 v[88:91], v[16:19], v[48:51], v[88:91]
    v_mfma_f32_16x16x32_bf16 v[92:95], v[32:35], v[48:51], v[92:95]
    s_waitcnt lgkmcnt(0)
    v_mfma_f32_16x16x32_bf16 v[88:91], v[20:23], v[52:55], v[88:91]
    v_mfma_f32_16x16x32_bf16 v[92:95], v[36:39], v[52:55], v[92:95]
    v_mfma_f32_16x16x32_bf16 v[96:99], v[8:11], v[56:59], 0
    v_mfma_f32_16x16x32_bf16 v[100:103], v[24:27], v[56:59], 0
    v_mfma_f32_16x16x32_bf16 v[96:99], v[12:15], v[60:63], v[96:99]
    v_mfma_f32_16x16x32_bf16 v[100:103], v[28:31], v[60:63], v[100:103]
    v_mfma_f32_16x16x32_bf16 v[96:99], v[16:19], v[64:67], v[96:99]
    v_mfma_f32_16x16x32_bf16 v[100:103], v[32:35], v[64:67], v[100:103]
    v_mfma_f32_16x16x32_bf16 v[96:99], v[20:23], v[68:71], v[96:99]
    v_mfma_f32_16x16x32_bf16 v[100:103], v[36:39], v[68:71], v[100:103]
    s_cbranch_scc0 L_two_g2
    v_mfma_f32_16x16x32_bf16 v[104:107], v[8:11], v[72:75], 0
    v_mfma_f32_16x16x32_bf16 v[108:111], v[24:27], v[72:75], 0
    v_mfma_f32_16x16x32_bf16 v[104:107], v[12:15], v[76:79], v[104:107]
    v_mfma_f32_16x16x32_bf16 v[108:111], v[28:31], v[76:79], v[108:111]
    v_mfma_f32_16x16x32_bf16 v[104:107], v[16:19], v[80:83], v[104:107]
    v_mfma_f32_16x16x32_bf16 v[108:111], v[32:35], v[80:83], v[108:111]
    v_mfma_f32_16x16x32_bf16 v[104:107], v[20:23], v[84:87], v[104:107]
    v_mfma_f32_16x16x32_bf16 v[108:111], v[36:39], v[84:87], v[108:111]
L_two_g2:
    v_mul_f32 v88, s40, v88
    v_mul_f32 v89, s40, v89
    v_mul_f32 v90, s40, v90
    v_mul_f32 v91, s40, v91
    ds_write_b128 v114, v[92:95] offset:256
    ds_write_b128 v114, v[88:91] offset:0
    s_nop 1
    v_mul_f32 v96, s40, v96
    v_mul_f32 v97, s40, v97
    v_mul_f32 v98, s40, v98
    v_mul_f32 v99, s40, v99
    ds_write_b128 v114, v[100:103] offset:8704
    ds_write_b128 v114, v[96:99] offset:8448
    s_cbranch_scc0 L_done_g2
    v_mul_f32 v104, s40, v104
    v_mul_f32 v105, s40, v105
    v_mul_f32 v106, s40, v106
    v_mul_f32 v107, s40, v107
    ds_write_b128 v114, v[108:111] offset:17152
    ds_write_b128 v114, v[104:107] offset:16896
    v_and_b32 v113, 0x3f0, v0
    v_lshlrev_b32 v113, 3, v113
    v_lshl_add_u32 v113, v0, 4, v113
    s_waitcnt vmcnt(0)
    s_barrier
    buffer_load_dwordx4 v[4:7], v113, s[20:23], s74 offen sc1
L_done_g2:
    s_mov_b32 s75, 0
    v_add_u32 v2, v119, v115
    ds_read_b32 v3, v2 offset:1536
    v_mov_b32 v2, 0
    ds_read_b32 v8, v2 offset:1284
    v_mov_b64 v[54:55], v[122:123]
    v_mov_b64 v[58:59], v[122:123]
    v_mov_b32 v64, 0
    v_mov_b32 v71, 0
    v_mov_b32 v76, 0
    v_mov_b32 v83, 0
    s_waitcnt lgkmcnt(0)
    v_cvt_pk_bf16_f32 v3, v2, v3
    v_readfirstlane_b32 s70, v8
    s_and_b32 s70, s70, 0x2000
    s_add_u32 s52, s52, s70
    v_mov_b32 v65, v3
    v_mov_b32 v70, v3
    v_mov_b32 v77, v3
    v_mov_b32 v82, v3
    s_lshl_b32 s47, s54, 4
    v_add_u32 v110, s47, v115
    v_add_u32 v111, s47, v125
    s_cmp_ge_u32 s32, 12
    s_cselect_b32 s78, 5, 0
    v_mov_b32 v67, v119
    v_mov_b32 v73, v119
    v_mov_b32 v79, v119
    v_mov_b32 v85, v119
    v_mov_b32 v16, 1.0
    v_mov_b32 v17, 1.0
    v_mov_b64 v[18:19], v[16:17]
    v_mov_b32 v27, 3
    s_movk_i32 s46, 0x7e
    s_movk_i32 s48, 0xfe
    s_lshl_b32 s49, s35, 1
    v_lshlrev_b32 v8, 3, v1
    v_lshlrev_b32 v9, 2, v1
    v_mov_b32 v10, 1
    v_add_u32 v11, 64, v1
    v_mov_b32 v14, 0
    s_mul_i32 s47, s32, 10
    v_add_u32 v2, s47, v1
    v_lshrrev_b32 v3, 1, v2
    v_and_b32 v2, 1, v2
    v_lshl_or_b32 v2, v2, 7, s71
    v_and_b32 v22, 96, v3
    v_add_u32 v3, v3, v22
    v_lshl_or_b32 v22, v3, 16, v2
    s_branch L_slotchk
L_initwave:
    s_setprio 2
    v_and_b32 v1, 31, v0
    v_mul_u32_u24 v12, 392, v1
    v_add_u32 v12, 88064, v12
    v_lshlrev_b32 v13, 2, v1
    v_add_u32 v13, 163328, v13
    ds_write_b32 v13, v12 offset:384
    v_lshlrev_b32 v13, 3, v1
    v_add_u32 v14, 100352, v13
    ds_write_b64 v14, v[8:9]
    s_add_u32 s44, s42, 65536
    v_and_b32 v3, 15, v0
    v_lshl_add_u32 v3, v3, 3, s44
    s_waitcnt lgkmcnt(0)
    s_lshl4_add_u32 s49, s2, s32
    s_mov_b32 s48, 26214400
    s_cmp_lg_u32 s49, 10
    s_cbranch_scc1 L_nowarmp
    s_load_dword s46, s[20:21], s48 glc
    s_load_dword s47, s[20:21], s48 offset:0x2000 glc
L_nowarmp:
    global_load_dwordx2 v[16:17], v3, s[16:17]
    s_barrier
    s_load_dword s38, s[20:21], s3
    ds_write_b64 v13, v[8:9] offset:1792
    v_mov_b32 v20, 0xa000
    v_mov_b32 v21, v20
    v_mov_b64 v[22:23], v[20:21]
    v_add_u32 v12, 90368, v2
    ds_write_b128 v12, v[20:23] offset:0
    ds_write_b128 v12, v[20:23] offset:2048
    ds_write_b128 v12, v[20:23] offset:4096
    ds_write_b128 v12, v[20:23] offset:6144
    ds_write_b128 v12, v[20:23] offset:8192
    ds_write_b128 v12, v[20:23] offset:10240
    ds_write_b128 v12, v[20:23] offset:12288
    ds_write_b128 v12, v[20:23] offset:14336
    s_cbranch_scc0 L_probe
L_probed:
    ds_write_b128 v12, v[20:23] offset:16384
    ds_write_b128 v12, v[20:23] offset:18432
    ds_write_b128 v12, v[20:23] offset:20480
    ds_write_b128 v12, v[20:23] offset:22528
    ds_write_b128 v12, v[20:23] offset:24576
    ds_write_b128 v12, v[20:23] offset:26624
    ds_write_b128 v12, v[20:23] offset:28672
    ds_write_b128 v12, v[20:23] offset:30720
    v_subrev_u32 v3, 640, v0
    v_mul_u32_u24 v5, 388, v3
    v_add_u32 v5, 100800, v5
    v_subrev_u32 v4, 4, v5
    v_lshlrev_b32 v6, 3, v3
    v_mov_b64 v[10:11], 0
    v_cmp_gt_u32 vcc, 80, v3
    s_mov_b64 exec, vcc
    ds_write_b64 v6, v[4:5] offset:64
    ds_write_b64 v6, v[10:11] offset:704
    s_mov_b64 exec, -1
    s_mov_b32 s22, 37748736
    s_mov_b32 s23, 0x20000
    s_mov_b32 s40, 0xbfb8aa3b
    s_mov_b32 s41, 0xbfb8aa3b
    s_and_b32 s37, s33, 3
    s_mov_b32 s52, 16777216
    s_and_b32 s71, s43, 0x6000
    s_add_u32 s71, s71, s43
    v_and_b32 v1, 63, v0
    v_and_b32 v2, 15, v0
    s_mov_b64 s[66:67], s[20:21]
    v_subrev_u32 v3, 512, v0
    v_mul_u32_u24 v4, 171, v3
    v_lshrrev_b32 v4, 12, v4
    v_mul_u32_u24 v26, 24, v4
    v_sub_u32 v26, v3, v26
    v_mul_u32_u24 v5, 784, v4
    v_add_u32 v5, 88064, v5
    v_lshrrev_b32 v6, 3, v26
    v_and_b32 v7, 7, v26
    v_cmp_eq_u32 vcc, 1, v6
    v_mul_u32_u24 v6, 196, v6
    v_lshl_add_u32 v6, v7, 3, v6
    v_mad_i32_i24 v25, v7, -8, v5
    v_add_u32 v25, 640, v25
    v_add_u32 v5, v5, v6
    v_subrev_u32 v6, 4, v5
    v_cndmask_b32 v5, v5, v6, vcc
    v_mov_b32 v6, 1792
    v_cndmask_b32 v25, v6, v25, vcc
    s_movk_i32 s45, 24192
    v_lshlrev_b32 v24, 4, v3
    v_mad_u32_u24 v24, v4, s45, v24
    v_lshlrev_b32 v7, 3, v2
    v_add_u32 v7, 163328, v7
    v_mul_u32_u24 v6, 784, v2
    v_add_u32 v6, 88448, v6
    v_add_u32 v27, 392, v6
    v_add_u32 v4, v6, v27
    v_subrev_u32 v4, 192, v4
    s_mov_b32 s72, 0x0c0c0400
    s_mov_b32 s73, 0x04000c0c
    s_mul_i32 s56, s37, 393216
    s_mul_i32 s45, s36, 384
    s_add_u32 s56, s56, s45
    s_add_u32 s56, s56, 5242880
    v_lshlrev_b32 v3, 4, v2
    s_waitcnt vmcnt(0)
L_gotc:
    v_lshlrev_b32 v28, 16, v16
    v_and_b32 v29, 0xffff0000, v16
    v_lshlrev_b32 v30, 16, v17
    v_and_b32 v31, 0xffff0000, v17
    v_pk_mul_f32 v[28:29], v[28:29], s[40:41]
    v_pk_mul_f32 v[30:31], v[30:31], s[40:41]
    ds_write_b128 v3, v[28:31] offset:1536
L_rb1:
    s_setprio 2
    s_waitcnt lgkmcnt(0)
    v_lshlrev_b32 v3, 3, v26
    v_lshrrev_b32 v3, v3, s38
    v_mad_u32_u24 v26, v26, 37, v3
    s_cmp_eq_u32 s32, 15
    s_cbranch_scc1 L_sel0
    s_cmp_ge_u32 s32, 14
    s_waitcnt vmcnt(8)
    s_barrier
    s_cbranch_scc1 L_norec
    ds_read_b64 v[14:15], v7 offset:384
    ds_read_b64 v[8:9], v5
    ds_read_b64 v[16:17], v25 offset:128
    ds_read_b64 v[12:13], v5 offset:64
    ds_read_b64 v[18:19], v25 offset:64
    ds_read_b64 v[10:11], v5 offset:128
    ds_read_b64 v[20:21], v25
    s_waitcnt lgkmcnt(4)
    v_cmp_gt_u32 vcc, v14, v6
    v_cmp_gt_u32 s[60:61], v15, v27
    v_add_u32 v14, v14, v15
    v_cmp_gt_u32 s[62:63], v14, v4
    v_and_b32 v8, v8, v16
    v_and_b32 v17, v9, v17
    s_or_b64 vcc, vcc, s[60:61]
    s_waitcnt lgkmcnt(0)
    v_and_b32 v13, v13, v19
    v_and_b32 v11, v11, v21
    s_or_b64 vcc, vcc, s[62:63]
    v_perm_b32 v13, v13, v17, s72
    v_perm_b32 v11, v26, v11, s73
    v_and_b32 v9, v12, v18
    v_and_b32 v10, v10, v20
    v_or_b32 v11, v11, v13
    s_cbranch_scc1 L_ovf
L_noovf:
    buffer_store_dwordx4 v[8:11], v24, s[20:23], s56 offen sc1
    s_branch L_norec
L_sel0:
    s_waitcnt vmcnt(11)
    s_load_dword s44, s[66:67], 0
    s_movk_i32 s45, 64
    v_mov_b32 v15, 0
    s_waitcnt vmcnt(8)
    s_barrier
    s_branch L_sel1
L_sel:
    s_cmp_ge_u32 s45, 256
    s_cbranch_scc1 L_selslow
    s_load_dword s44, s[66:67], s45
    s_add_u32 s45, s45, 64
L_sel1:
    s_waitcnt lgkmcnt(0)
    s_cmp_eq_u32 s44, 0
    s_cbranch_scc1 L_sel
L_selok:
    s_xor_b32 s44, s44, s34
    s_and_b32 s44, s44, 1
    s_lshl_b32 s44, s44, 13
    s_or_b32 s44, s44, 1
    v_mov_b32 v28, s44
    ds_write_b32 v15, v28 offset:1284
    s_waitcnt lgkmcnt(0)
L_norec:
    s_setprio 0
    s_and_b32 s51, s35, 1
    s_mul_i32 s74, s51, 296
    v_lshlrev_b32 v127, 3, v2
    v_lshrrev_b32 v127, v127, s38
    v_mad_u32_u24 v127, v2, 37, v127
    v_add_u32 v127, s74, v127
    s_add_u32 s38, s38, 0x01010101
    s_lshr_b32 s74, s35, 1
    s_mul_i32 s74, s74, 192
    s_add_u32 s74, s74, s51
    s_lshl_b32 s74, s74, 7
    v_and_b32 v127, 0xff, v127
    s_add_u32 s74, s74, 5242880
    s_mul_i32 s51, s51, 0x808080
    v_and_b32 v20, 1, v1
    v_lshlrev_b32 v20, 4, v20
    v_mov_b32 v21, 0x3f80
    v_lshlrev_b32 v21, v20, v21
    v_and_b32 v20, 2, v1
    v_cmp_eq_u32 vcc, 0, v20
    v_lshlrev_b32 v119, 4, v2
    v_lshrrev_b32 v115, 4, v1
    v_cndmask_b32 v116, 0, v21, vcc
    v_sub_u32 v117, v21, v116
    v_lshlrev_b32 v115, 2, v115
    v_mov_b32 v121, v119
    v_and_b32 v125, 12, v1
    v_cmp_eq_u32 vcc, v125, v115
    v_and_b32 v20, 3, v1
    v_lshlrev_b32 v20, 2, v20
    v_cndmask_b32 v122, 0, v116, vcc
    v_cndmask_b32 v123, 0, v117, vcc
    v_cmp_ne_u32 vcc, v20, v115
    v_mov_b32 v21, 0x100000
    s_mov_b32 s76, 16
    s_mov_b32 s77, 16
    v_cndmask_b32 v126, 0, v21, vcc
    s_mov_b32 s46, 0x45673210
    s_mov_b32 s47, 0xcdefa98b
    s_lshl_b32 s54, s32, 2
    s_lshr_b64 s[46:47], s[46:47], s54
    s_and_b32 s54, s46, 15
    s_add_u32 s57, s43, s42
    s_add_u32 s24, s20, s52
    s_addc_u32 s25, s21, 0x1000000
    s_mov_b32 s26, 36864
    s_mov_b32 s27, 0x20000
    s_mov_b64 s[28:29], s[18:19]
    s_mov_b32 s30, 2560000
    s_mov_b32 s31, 0x20000
    s_mov_b64 s[58:59], 0
    s_mov_b32 s68, 0
    s_cmp_lt_u32 s32, 14
    s_waitcnt vmcnt(1)
    s_cbranch_scc1 L_rbm
    s_waitcnt vmcnt(0)
L_rbm:
    v_and_b32 v113, 0x3f0, v0
    v_lshlrev_b32 v113, 3, v113
    v_lshl_add_u32 v113, v0, 4, v113
    s_barrier
    buffer_load_dwordx4 v[4:7], v113, s[20:23], s74 offen sc1
    v_add_u32 v2, v119, v115
    ds_read_b32 v3, v2 offset:1536
    v_mov_b32 v2, 0
    ds_read_b32 v8, v2 offset:1284
    v_mov_b64 v[54:55], v[122:123]
    v_mov_b64 v[58:59], v[122:123]
    v_mov_b32 v64, 0
    v_mov_b32 v71, 0
    v_mov_b32 v76, 0
    v_mov_b32 v83, 0
    s_waitcnt lgkmcnt(0)
    v_cvt_pk_bf16_f32 v3, v2, v3
    v_readfirstlane_b32 s70, v8
    s_and_b32 s70, s70, 0x2000
    s_add_u32 s52, s52, s70
    v_mov_b32 v65, v3
    v_mov_b32 v70, v3
    v_mov_b32 v77, v3
    v_mov_b32 v82, v3
    s_lshl_b32 s47, s54, 4
    v_add_u32 v110, s47, v115
    v_add_u32 v111, s47, v125
    s_cmp_ge_u32 s32, 12
    s_cselect_b32 s78, 5, 0
    v_mov_b32 v67, v119
    v_mov_b32 v73, v119
    v_mov_b32 v79, v119
    v_mov_b32 v85, v119
    v_mov_b32 v16, 1.0
    v_mov_b32 v17, 1.0
    v_mov_b64 v[18:19], v[16:17]
    v_mov_b32 v27, 3
    s_movk_i32 s46, 0x7e
    s_movk_i32 s48, 0xfe
    s_lshl_b32 s49, s35, 1
    v_lshlrev_b32 v8, 3, v1
    v_lshlrev_b32 v9, 2, v1
    v_mov_b32 v10, 1
    v_add_u32 v11, 64, v1
    v_mov_b32 v14, 0
    s_mul_i32 s47, s32, 10
    v_add_u32 v2, s47, v1
    v_lshrrev_b32 v3, 1, v2
    v_and_b32 v2, 1, v2
    v_lshl_or_b32 v2, v2, 7, s71
    v_and_b32 v22, 96, v3
    v_add_u32 v3, v3, v22
    v_lshl_or_b32 v22, v3, 16, v2
    s_min_u32 s44, s2, 1
    s_add_u32 s44, s44, 14
    s_cmp_ge_u32 s32, s44
    s_cselect_b32 s75, 1, 0
    s_and_b32 s39, s2, 3
    s_lshl_b32 s39, s39, 15
    s_sub_u32 s44, 15, s32
    s_lshl_b32 s44, s44, 13
    s_xor_b32 s44, s44, s70
    s_add_u32 s39, s39, s44
    s_add_u32 s39, s39, 26738688
    s_add_u32 s69, s39, 16384
    v_and_b32 v113, 0x3f0, v0
    v_lshlrev_b32 v113, 3, v113
    v_lshl_add_u32 v113, v0, 4, v113
    v_lshrrev_b32 v20, 4, v1
    v_mul_u32_u24 v20, 32768, v20
    v_and_b32 v21, 15, v1
    v_lshl_add_u32 v20, v21, 3, v20
    v_mov_b32 v24, s38
    v_mov_b32 v25, s38
    s_and_b32 s44, s35, 64
    s_add_u32 s44, s44, s35
    s_lshl_b32 s44, s44, 7
    s_add_u32 s44, s44, s70
    s_add_u32 s44, s44, 26738688
    s_cmp_lg_u32 s32, 8
    s_cbranch_scc1 L_noflag
    s_setprio 3
    s_barrier
    buffer_store_dwordx2 v[24:25], v20, s[20:23], s44 offen sc1
    s_setprio 0
    s_waitcnt vmcnt(1)
    s_branch L_slotchk1
L_noflag:
    s_barrier
L_slotchk:
    s_waitcnt vmcnt(0)
L_slotchk1:
    v_cmp_ne_u32_sdwa vcc, v127, v7 src0_sel:DWORD src1_sel:BYTE_3
L_slotok:
    v_cmp_eq_u32_sdwa s[66:67], s48, v7 src0_sel:DWORD src1_sel:BYTE_0
    v_xor_b32 v7, s51, v7
    v_cmp_gt_u32_sdwa s[60:61], s46, v7 src0_sel:DWORD src1_sel:BYTE_0
    v_lshlrev_b32_sdwa v12, v27, v7 dst_sel:DWORD dst_unused:UNUSED_PAD src0_sel:DWORD src1_sel:BYTE_0
    v_xor_b32 v25, s49, v4
    v_bfe_u32 v25, v25, 7, 1
    v_lshl_add_u32 v12, v25, 2, v12
    v_lshl_add_u32 v25, v25, 3, -4
    s_cbranch_vccnz L_slotretry
    s_mov_b64 exec, s[60:61]
    ds_add_rtn_u32 v12, v12, v25 offset:64
    s_mov_b64 exec, -1
    v_cmp_gt_u32_sdwa s[62:63], s46, v7 src0_sel:DWORD src1_sel:BYTE_1
    v_lshlrev_b32_sdwa v13, v27, v7 dst_sel:DWORD dst_unused:UNUSED_PAD src0_sel:DWORD src1_sel:BYTE_1
    v_xor_b32 v26, s49, v5
    v_bfe_u32 v26, v26, 7, 1
    v_lshl_add_u32 v13, v26, 2, v13
    v_lshl_add_u32 v26, v26, 3, -4
    s_mov_b64 exec, s[62:63]
    ds_add_rtn_u32 v13, v13, v26 offset:64
    s_mov_b64 exec, -1
    v_cmp_gt_u32_sdwa s[64:65], s46, v7 src0_sel:DWORD src1_sel:BYTE_2
    v_lshlrev_b32_sdwa v15, v27, v7 dst_sel:DWORD dst_unused:UNUSED_PAD src0_sel:DWORD src1_sel:BYTE_2
    v_xor_b32 v3, s49, v6
    v_bfe_u32 v3, v3, 7, 1
    v_lshl_add_u32 v15, v3, 2, v15
    v_lshl_add_u32 v3, v3, 3, -4
    s_mov_b64 exec, s[64:65]
    ds_add_rtn_u32 v15, v15, v3 offset:64
    s_mov_b64 exec, -1
    s_cmp_lg_u64 s[66:67], 0
    s_cbranch_scc1 L_mark
L_nomark:
    s_cmp_lg_u32 s32, 0
    s_waitcnt lgkmcnt(0)
    s_cbranch_scc1 L_nosort
    s_setprio 3
    s_movk_i32 s44, 256
    s_barrier
    ds_read_b64 v[28:29], v8 offset:64
    ds_read_b64 v[30:31], v8 offset:576
    ds_read_b32 v14, v14 offset:1280
    s_waitcnt lgkmcnt(1)
    v_sub_u32 v29, v29, v28
    v_sub_u32 v31, v31, v30
    v_sub_u32_e64 v29, s44, v29 clamp
    v_sub_u32_e64 v31, s44, v31 clamp
    ds_add_rtn_u32 v32, v29, v10 offset:704
    s_mov_b64 exec, 0xffff
    ds_add_rtn_u32 v33, v31, v10 offset:704
    s_mov_b64 exec, -1
    ds_read_b32 v35, v9 offset:704
    v_lshl_or_b32 v36, v29, 8, v1
    v_lshl_or_b32 v37, v31, 8, v11
    v_lshl_or_b32 v28, v28, 14, v36
    v_lshl_or_b32 v30, v30, 14, v37
    s_waitcnt lgkmcnt(0)
    v_add_u32_dpp v34, v35, v35 row_shr:1 row_mask:0xf bank_mask:0xf bound_ctrl:1
    s_nop 1
    v_add_u32_dpp v34, v34, v34 row_shr:2 row_mask:0xf bank_mask:0xf bound_ctrl:1
    s_nop 1
    v_add_u32_dpp v34, v34, v34 row_shr:4 row_mask:0xf bank_mask:0xf bound_ctrl:1
    s_nop 1
    v_add_u32_dpp v34, v34, v34 row_shr:8 row_mask:0xf bank_mask:0xf bound_ctrl:1
    s_nop 1
    v_add_u32_dpp v34, v34, v34 row_bcast:15 row_mask:0xa bank_mask:0xf
    s_nop 1
    v_add_u32_dpp v34, v34, v34 row_bcast:31 row_mask:0xc bank_mask:0xf
    v_sub_u32 v34, v34, v35
    ds_bpermute_b32 v29, v29, v34
    ds_bpermute_b32 v31, v31, v34
    v_readlane_b32 s44, v34, 15
    v_readfirstlane_b32 s45, v14
    s_mov_b64 exec, s[60:61]
    ds_write_b32 v12, v4
    s_mov_b64 exec, s[62:63]
    ds_write_b32 v13, v5
    s_mov_b64 exec, s[64:65]
    ds_write_b32 v15, v6
    s_mov_b64 exec, -1
    s_or_b32 s44, s44, s45
    s_cselect_b32 s44, 0x80, 0
    v_or_b32 v28, s44, v28
    v_or_b32 v30, s44, v30
    s_waitcnt lgkmcnt(0)
    v_add_lshl_u32 v29, v29, v32, 2
    v_add_lshl_u32 v31, v31, v33, 2
    ds_write_b32 v29, v28 offset:960
    s_mov_b64 exec, 0xffff
    ds_write_b32 v31, v30 offset:960
    s_mov_b64 exec, -1
    s_setprio 0
    s_branch L_sorted
L_nosort:
    s_barrier
    s_cmp_eq_u32 s75, 0
    s_cbranch_scc1 L_nopoll0
    v_lshlrev_b32 v2, 7, v1
    buffer_load_dword v44, v2, s[20:23], s39 offen sc1
    buffer_load_dword v45, v2, s[20:23], s69 offen sc1
L_nopoll0:
    s_mov_b64 exec, s[60:61]
    ds_write_b32 v12, v4
    s_mov_b64 exec, s[62:63]
    ds_write_b32 v13, v5
    s_mov_b64 exec, s[64:65]
    ds_write_b32 v15, v6
    s_mov_b64 exec, 255
    buffer_load_dword v124, v22, s[20:23], s52 offen sc1
    s_mov_b64 exec, -1
    s_cmp_lt_u32 s32, 12
    s_cbranch_scc1 L_sorted
    s_setprio 3
L_sorted:
    s_waitcnt lgkmcnt(0)
    s_barrier
L_batch:
    ds_read_b32 v23, v110 offset:960
    ds_read_u16 v21, v111 offset:962
    s_waitcnt lgkmcnt(1)
    v_lshrrev_b32 v20, 16, v23
    v_lshlrev_b32 v20, 2, v20
    v_readfirstlane_b32 s55, v23
    ds_read_u16 v66, v20 offset:4
    ds_read_u16 v72, v20 offset:8
    ds_read_u16 v78, v20 offset:12
    ds_read_u16 v84, v20 offset:16
    s_cmp_ge_u32 s54, 16
    s_cbranch_scc1 L_go
    s_cmp_eq_u32 s75, 0
    s_cbranch_scc1 L_b5
    s_waitcnt vmcnt(1)
    s_branch L_poll1
L_poll:
    s_mov_b64 exec, vcc
    buffer_load_dword v44, v2, s[20:23], s39 offen sc1
    s_mov_b64 exec, s[60:61]
    buffer_load_dword v45, v2, s[20:23], s69 offen sc1
    s_mov_b64 exec, -1
    s_add_u32 s58, s58, 1
    s_cmp_ge_u32 s58, 2097152
    s_cbranch_scc1 L_pollok
    s_waitcnt vmcnt(0)
L_poll1:
    v_cmp_ne_u32 vcc, s38, v44
    v_cmp_ne_u32 s[60:61], s38, v45
    s_or_b64 s[62:63], vcc, s[60:61]
    s_cbranch_scc1 L_poll
L_pollok:
    s_cmp_lg_u32 s32, 14
    s_cbranch_scc1 L_b5
    s_barrier
    s_mov_b64 exec, 1
    v_mov_b32 v3, s38
    buffer_store_dword v3, off, s[20:23], s3 sc1
    s_mov_b64 exec, -1
    s_branch L_go
L_b5:
    s_barrier
L_go:
    s_waitcnt lgkmcnt(0)
    buffer_load_dwordx4 v[66:69], v[66:67], s[24:27], s70 idxen offen sc1
    buffer_load_dwordx4 v[72:75], v[72:73], s[24:27], s70 idxen offen sc1
    buffer_load_dwordx4 v[78:81], v[78:79], s[24:27], s70 idxen offen sc1
    buffer_load_dwordx4 v[84:87], v[84:85], s[24:27], s70 idxen offen sc1
L_go2:
    v_lshl_add_u32 v21, v21, 2, v126
    v_and_b32 v2, 0x7f, v23
    v_mul_u32_u24 v3, 528, v2
    v_add_u32 v3, v3, v119
    ds_read2_b32 v[56:57], v21 offset0:0 offset1:1
    ds_read2_b32 v[52:53], v21 offset0:2 offset1:3
    ds_read_b128 v[8:11], v3 offset:34816
    ds_read_b128 v[12:15], v3 offset:35072
    ds_read_u16 v118, v20 offset:20
    ds_read_u16 v120, v20 offset:24
    v_lshrrev_b32 v22, 1, v119
    v_lshl_or_b32 v22, v2, 15, v22
    s_bitcmp1_b32 s55, 7
    s_cbranch_scc1 L_scan
    s_bfe_u32 s55, s55, 0x6000a
    s_min_u32 s55, s55, 58
    s_sub_u32 s55, 58, s55
    s_lshr_b32 s50, s55, 1
    s_cmp_eq_u32 s78, 0
    s_cbranch_scc1 L_nodb
    ds_read_b32 v100, v110 offset:1024
    ds_read_u16 v101, v111 offset:1026
    v_mov_b32 v89, v119
    v_mov_b32 v91, v119
    v_mov_b32 v93, v119
    v_mov_b32 v95, v119
    s_waitcnt lgkmcnt(1)
    v_lshrrev_b32 v102, 16, v100
    v_lshlrev_b32 v102, 2, v102
    ds_read_u16 v88, v102 offset:4
    ds_read_u16 v90, v102 offset:8
    ds_read_u16 v92, v102 offset:12
    ds_read_u16 v94, v102 offset:16
L_nodb:
    s_sub_i32 s79, 6, s78
    s_setprio 3
    s_cmp_gt_i32 s50, s79
    s_cbranch_scc1 L_lad
    s_sub_i32 s79, 4, s78
    s_setprio 2
    s_cmp_gt_i32 s50, s79
    s_cbranch_scc1 L_lad
    s_movk_i32 s79, -100
    s_setprio 1
L_lad:
    s_waitcnt vmcnt(3) lgkmcnt(0)
    v_mfma_f32_16x16x32_bf16 v[28:31], v[56:59], v[64:67], v[8:11]
    v_mfma_f32_4x4x4_16b_bf16 v[36:39], v[116:117], v[68:69], 0
    s_sub_u32 s50, s50, 1
    buffer_load_dwordx4 v[66:69], v[118:119], s[24:27], s70 idxen offen sc1
    ds_read_u16 v118, v20 offset:28
    s_nop 1
    s_cbranch_scc1 L_drain0
L_loop:
    s_waitcnt vmcnt(3) lgkmcnt(1)
    v_mfma_f32_16x16x32_bf16 v[32:35], v[52:55], v[70:73], v[8:11]
    v_exp_f32 v44, v28
    v_exp_f32 v45, v29
    v_mfma_f32_4x4x4_16b_bf16 v[40:43], v[116:117], v[74:75], 0
    v_exp_f32 v46, v30
    v_exp_f32 v47, v31
    ds_read2_b32 v[56:57], v21 offset0:4 offset1:5
    v_pk_fma_f32 v[48:49], v[36:37], v[16:17], v[12:13]
    v_pk_fma_f32 v[50:51], v[38:39], v[18:19], v[14:15]
    v_pk_fma_f32 v[16:17], v[16:17], v[44:45], v[16:17]
    v_pk_fma_f32 v[18:19], v[18:19], v[46:47], v[18:19]
    v_pk_fma_f32 v[12:13], v[12:13], v[44:45], v[48:49]
    v_pk_fma_f32 v[14:15], v[14:15], v[46:47], v[50:51]
    buffer_load_dwordx4 v[72:75], v[120:121], s[24:27], s70 idxen offen sc1
    ds_read_u16 v120, v20 offset:32
    s_waitcnt vmcnt(3) lgkmcnt(2)
    v_mfma_f32_16x16x32_bf16 v[28:31], v[52:55], v[76:79], v[8:11]
    v_exp_f32 v44, v32
    v_exp_f32 v45, v33
    v_mfma_f32_4x4x4_16b_bf16 v[36:39], v[116:117], v[80:81], 0
    v_exp_f32 v46, v34
    v_exp_f32 v47, v35
    v_pk_fma_f32 v[48:49], v[40:41], v[16:17], v[12:13]
    v_pk_fma_f32 v[50:51], v[42:43], v[18:19], v[14:15]
    v_pk_fma_f32 v[16:17], v[16:17], v[44:45], v[16:17]
    v_pk_fma_f32 v[18:19], v[18:19], v[46:47], v[18:19]
    v_pk_fma_f32 v[12:13], v[12:13], v[44:45], v[48:49]
    v_pk_fma_f32 v[14:15], v[14:15], v[46:47], v[50:51]
    buffer_load_dwordx4 v[78:81], v[118:119], s[24:27], s70 idxen offen sc1
    ds_read_u16 v118, v20 offset:36
    s_sub_u32 s50, s50, 1
    s_cbranch_scc1 L_drain2
    s_waitcnt vmcnt(3) lgkmcnt(1)
    v_mfma_f32_16x16x32_bf16 v[32:35], v[56:59], v[82:85], v[8:11]
    v_exp_f32 v44, v28
    v_exp_f32 v45, v29
    v_mfma_f32_4x4x4_16b_bf16 v[40:43], v[116:117], v[86:87], 0
    v_exp_f32 v46, v30
    v_exp_f32 v47, v31
    ds_read2_b32 v[52:53], v21 offset0:6 offset1:7
    v_pk_fma_f32 v[48:49], v[36:37], v[16:17], v[12:13]
    v_pk_fma_f32 v[50:51], v[38:39], v[18:19], v[14:15]
    v_pk_fma_f32 v[16:17], v[16:17], v[44:45], v[16:17]
    v_pk_fma_f32 v[18:19], v[18:19], v[46:47], v[18:19]
    v_pk_fma_f32 v[12:13], v[12:13], v[44:45], v[48:49]
    v_pk_fma_f32 v[14:15], v[14:15], v[46:47], v[50:51]
    buffer_load_dwordx4 v[84:87], v[120:121], s[24:27], s70 idxen offen sc1
    ds_read_u16 v120, v20 offset:40
    s_waitcnt vmcnt(3) lgkmcnt(2)
    v_mfma_f32_16x16x32_bf16 v[28:31], v[56:59], v[64:67], v[8:11]
    v_exp_f32 v44, v32
    v_exp_f32 v45, v33
    v_mfma_f32_4x4x4_16b_bf16 v[36:39], v[116:117], v[68:69], 0
    v_exp_f32 v46, v34
    v_exp_f32 v47, v35
    v_pk_fma_f32 v[48:49], v[40:41], v[16:17], v[12:13]
    v_pk_fma_f32 v[50:51], v[42:43], v[18:19], v[14:15]
    v_pk_fma_f32 v[16:17], v[16:17], v[44:45], v[16:17]
    v_pk_fma_f32 v[18:19], v[18:19], v[46:47], v[18:19]
    v_pk_fma_f32 v[12:13], v[12:13], v[44:45], v[48:49]
    v_pk_fma_f32 v[14:15], v[14:15], v[46:47], v[50:51]
    buffer_load_dwordx4 v[66:69], v[118:119], s[24:27], s70 idxen offen sc1
    ds_read_u16 v118, v20 offset:44
    v_lshl_add_u64 v[20:21], v[20:21], 0, s[76:77]
    s_cmp_le_i32 s50, s79
    s_cbranch_scc1 L_lower
L_lowered:
    s_sub_u32 s50, s50, 1
    s_cbranch_scc0 L_loop
L_drain0:
    s_bitcmp0_b32 s55, 0
    s_cbranch_scc1 L_even0
    s_waitcnt vmcnt(3) lgkmcnt(1)
    v_mfma_f32_16x16x32_bf16 v[32:35], v[52:55], v[70:73], v[8:11]
    v_exp_f32 v44, v28
    v_exp_f32 v45, v29
    v_mfma_f32_4x4x4_16b_bf16 v[40:43], v[116:117], v[74:75], 0
    v_exp_f32 v46, v30
    v_exp_f32 v47, v31
    ds_read2_b32 v[56:57], v21 offset0:4 offset1:5
    v_pk_fma_f32 v[48:49], v[36:37], v[16:17], v[12:13]
    v_pk_fma_f32 v[50:51], v[38:39], v[18:19], v[14:15]
    v_pk_fma_f32 v[16:17], v[16:17], v[44:45], v[16:17]
    v_pk_fma_f32 v[18:19], v[18:19], v[46:47], v[18:19]
    v_pk_fma_f32 v[12:13], v[12:13], v[44:45], v[48:49]
    v_pk_fma_f32 v[14:15], v[14:15], v[46:47], v[50:51]
    buffer_load_dwordx4 v[72:75], v[120:121], s[24:27], s70 idxen offen sc1
    s_cmp_lg_u32 s78, 0
    s_cbranch_scc1 L_keep1
    s_setprio 0
L_keep1:
    s_waitcnt vmcnt(3)
    v_mfma_f32_16x16x32_bf16 v[28:31], v[52:55], v[76:79], v[8:11]
    v_exp_f32 v44, v32
    v_exp_f32 v45, v33
    v_mfma_f32_4x4x4_16b_bf16 v[36:39], v[116:117], v[80:81], 0
    v_exp_f32 v46, v34
    v_exp_f32 v47, v35
    v_pk_fma_f32 v[48:49], v[40:41], v[16:17], v[12:13]
    v_pk_fma_f32 v[50:51], v[42:43], v[18:19], v[14:15]
    v_pk_fma_f32 v[16:17], v[16:17], v[44:45], v[16:17]
    v_pk_fma_f32 v[18:19], v[18:19], v[46:47], v[18:19]
    v_pk_fma_f32 v[12:13], v[12:13], v[44:45], v[48:49]
    v_pk_fma_f32 v[14:15], v[14:15], v[46:47], v[50:51]
    s_waitcnt vmcnt(2) lgkmcnt(0)
    v_mfma_f32_16x16x32_bf16 v[32:35], v[56:59], v[82:85], v[8:11]
    v_exp_f32 v44, v28
    v_exp_f32 v45, v29
    v_mfma_f32_4x4x4_16b_bf16 v[40:43], v[116:117], v[86:87], 0
    v_exp_f32 v46, v30
    v_exp_f32 v47, v31
    ds_read2_b32 v[52:53], v21 offset0:6 offset1:7
    v_pk_fma_f32 v[48:49], v[36:37], v[16:17], v[12:13]
    v_pk_fma_f32 v[50:51], v[38:39], v[18:19], v[14:15]
    v_pk_fma_f32 v[16:17], v[16:17], v[44:45], v[16:17]
    v_pk_fma_f32 v[18:19], v[18:19], v[46:47], v[18:19]
    v_pk_fma_f32 v[12:13], v[12:13], v[44:45], v[48:49]
    v_pk_fma_f32 v[14:15], v[14:15], v[46:47], v[50:51]
    s_waitcnt vmcnt(1)
    v_mfma_f32_16x16x32_bf16 v[28:31], v[56:59], v[64:67], v[8:11]
    v_exp_f32 v44, v32
    v_exp_f32 v45, v33
    v_mfma_f32_4x4x4_16b_bf16 v[36:39], v[116:117], v[68:69], 0
    v_exp_f32 v46, v34
    v_exp_f32 v47, v35
    v_pk_fma_f32 v[48:49], v[40:41], v[16:17], v[12:13]
    v_pk_fma_f32 v[50:51], v[42:43], v[18:19], v[14:15]
    v_pk_fma_f32 v[16:17], v[16:17], v[44:45], v[16:17]
    v_pk_fma_f32 v[18:19], v[18:19], v[46:47], v[18:19]
    v_pk_fma_f32 v[12:13], v[12:13], v[44:45], v[48:49]
    v_pk_fma_f32 v[14:15], v[14:15], v[46:47], v[50:51]
    s_waitcnt vmcnt(0) lgkmcnt(0)
    v_mfma_f32_16x16x32_bf16 v[32:35], v[52:55], v[70:73], v[8:11]
    v_exp_f32 v44, v28
    v_exp_f32 v45, v29
    v_mfma_f32_4x4x4_16b_bf16 v[40:43], v[116:117], v[74:75], 0
    v_exp_f32 v46, v30
    v_exp_f32 v47, v31
    v_pk_fma_f32 v[48:49], v[36:37], v[16:17], v[12:13]
    v_pk_fma_f32 v[50:51], v[38:39], v[18:19], v[14:15]
    v_pk_fma_f32 v[16:17], v[16:17], v[44:45], v[16:17]
    v_pk_fma_f32 v[18:19], v[18:19], v[46:47], v[18:19]
    v_pk_fma_f32 v[12:13], v[12:13], v[44:45], v[48:49]
    v_pk_fma_f32 v[14:15], v[14:15], v[46:47], v[50:51]
    v_exp_f32 v44, v32
    v_exp_f32 v45, v33
    v_exp_f32 v46, v34
    v_exp_f32 v47, v35
    v_pk_fma_f32 v[48:49], v[40:41], v[16:17], v[12:13]
    v_pk_fma_f32 v[50:51], v[42:43], v[18:19], v[14:15]
    v_pk_fma_f32 v[16:17], v[16:17], v[44:45], v[16:17]
    v_pk_fma_f32 v[18:19], v[18:19], v[46:47], v[18:19]
    v_pk_fma_f32 v[12:13], v[12:13], v[44:45], v[48:49]
    v_pk_fma_f32 v[14:15], v[14:15], v[46:47], v[50:51]
    s_branch L_loop_done
L_even0:
    s_cmp_lg_u32 s78, 0
    s_cbranch_scc1 L_keep0
    s_setprio 0
L_keep0:
    s_waitcnt vmcnt(3) lgkmcnt(0)
    v_mfma_f32_16x16x32_bf16 v[32:35], v[52:55], v[70:73], v[8:11]
    v_exp_f32 v44, v28
    v_exp_f32 v45, v29
    v_mfma_f32_4x4x4_16b_bf16 v[40:43], v[116:117], v[74:75], 0
    v_exp_f32 v46, v30
    v_exp_f32 v47, v31
    ds_read2_b32 v[56:57], v21 offset0:4 offset1:5
    v_pk_fma_f32 v[48:49], v[36:37], v[16:17], v[12:13]
    v_pk_fma_f32 v[50:51], v[38:39], v[18:19], v[14:15]
    v_pk_fma_f32 v[16:17], v[16:17], v[44:45], v[16:17]
    v_pk_fma_f32 v[18:19], v[18:19], v[46:47], v[18:19]
    v_pk_fma_f32 v[12:13], v[12:13], v[44:45], v[48:49]
    v_pk_fma_f32 v[14:15], v[14:15], v[46:47], v[50:51]
    s_waitcnt vmcnt(2)
    v_mfma_f32_16x16x32_bf16 v[28:31], v[52:55], v[76:79], v[8:11]
    v_exp_f32 v44, v32
    v_exp_f32 v45, v33
    v_mfma_f32_4x4x4_16b_bf16 v[36:39], v[116:117], v[80:81], 0
    v_exp_f32 v46, v34
    v_exp_f32 v47, v35
    v_pk_fma_f32 v[48:49], v[40:41], v[16:17], v[12:13]
    v_pk_fma_f32 v[50:51], v[42:43], v[18:19], v[14:15]
    v_pk_fma_f32 v[16:17], v[16:17], v[44:45], v[16:17]
    v_pk_fma_f32 v[18:19], v[18:19], v[46:47], v[18:19]
    v_pk_fma_f32 v[12:13], v[12:13], v[44:45], v[48:49]
    v_pk_fma_f32 v[14:15], v[14:15], v[46:47], v[50:51]
    s_waitcnt vmcnt(1) lgkmcnt(0)
    v_mfma_f32_16x16x32_bf16 v[32:35], v[56:59], v[82:85], v[8:11]
    v_exp_f32 v44, v28
    v_exp_f32 v45, v29
    v_mfma_f32_4x4x4_16b_bf16 v[40:43], v[116:117], v[86:87], 0
    v_exp_f32 v46, v30
    v_exp_f32 v47, v31
    v_pk_fma_f32 v[48:49], v[36:37], v[16:17], v[12:13]
    v_pk_fma_f32 v[50:51], v[38:39], v[18:19], v[14:15]
    v_pk_fma_f32 v[16:17], v[16:17], v[44:45], v[16:17]
    v_pk_fma_f32 v[18:19], v[18:19], v[46:47], v[18:19]
    v_pk_fma_f32 v[12:13], v[12:13], v[44:45], v[48:49]
    v_pk_fma_f32 v[14:15], v[14:15], v[46:47], v[50:51]
    s_waitcnt vmcnt(0)
    v_mfma_f32_16x16x32_bf16 v[28:31], v[56:59], v[64:67], v[8:11]
    v_exp_f32 v44, v32
    v_exp_f32 v45, v33
    v_mfma_f32_4x4x4_16b_bf16 v[36:39], v[116:117], v[68:69], 0
    v_exp_f32 v46, v34
    v_exp_f32 v47, v35
    v_pk_fma_f32 v[48:49], v[40:41], v[16:17], v[12:13]
    v_pk_fma_f32 v[50:51], v[42:43], v[18:19], v[14:15]
    v_pk_fma_f32 v[16:17], v[16:17], v[44:45], v[16:17]
    v_pk_fma_f32 v[18:19], v[18:19], v[46:47], v[18:19]
    v_pk_fma_f32 v[12:13], v[12:13], v[44:45], v[48:49]
    v_pk_fma_f32 v[14:15], v[14:15], v[46:47], v[50:51]
    v_exp_f32 v44, v28
    v_exp_f32 v45, v29
    v_exp_f32 v46, v30
    v_exp_f32 v47, v31
    v_pk_fma_f32 v[48:49], v[36:37], v[16:17], v[12:13]
    v_pk_fma_f32 v[50:51], v[38:39], v[18:19], v[14:15]
    v_pk_fma_f32 v[16:17], v[16:17], v[44:45], v[16:17]
    v_pk_fma_f32 v[18:19], v[18:19], v[46:47], v[18:19]
    v_pk_fma_f32 v[12:13], v[12:13], v[44:45], v[48:49]
    v_pk_fma_f32 v[14:15], v[14:15], v[46:47], v[50:51]
    s_branch L_loop_done
L_drain2:
    s_bitcmp0_b32 s55, 0
    s_cbranch_scc1 L_even2
    s_waitcnt vmcnt(3) lgkmcnt(1)
    v_mfma_f32_16x16x32_bf16 v[32:35], v[56:59], v[82:85], v[8:11]
    v_exp_f32 v44, v28
    v_exp_f32 v45, v29
    v_mfma_f32_4x4x4_16b_bf16 v[40:43], v[116:117], v[86:87], 0
    v_exp_f32 v46, v30
    v_exp_f32 v47, v31
    ds_read2_b32 v[52:53], v21 offset0:6 offset1:7
    v_pk_fma_f32 v[48:49], v[36:37], v[16:17], v[12:13]
    v_pk_fma_f32 v[50:51], v[38:39], v[18:19], v[14:15]
    v_pk_fma_f32 v[16:17], v[16:17], v[44:45], v[16:17]
    v_pk_fma_f32 v[18:19], v[18:19], v[46:47], v[18:19]
    v_pk_fma_f32 v[12:13], v[12:13], v[44:45], v[48:49]
    v_pk_fma_f32 v[14:15], v[14:15], v[46:47], v[50:51]
    buffer_load_dwordx4 v[84:87], v[120:121], s[24:27], s70 idxen offen sc1
    s_cmp_lg_u32 s78, 0
    s_cbranch_scc1 L_keep3
    s_setprio 0
L_keep3:
    s_waitcnt vmcnt(3)
    v_mfma_f32_16x16x32_bf16 v[28:31], v[56:59], v[64:67], v[8:11]
    v_exp_f32 v44, v32
    v_exp_f32 v45, v33
    v_mfma_f32_4x4x4_16b_bf16 v[36:39], v[116:117], v[68:69], 0
    v_exp_f32 v46, v34
    v_exp_f32 v47, v35
    v_pk_fma_f32 v[48:49], v[40:41], v[16:17], v[12:13]
    v_pk_fma_f32 v[50:51], v[42:43], v[18:19], v[14:15]
    v_pk_fma_f32 v[16:17], v[16:17], v[44:45], v[16:17]
    v_pk_fma_f32 v[18:19], v[18:19], v[46:47], v[18:19]
    v_pk_fma_f32 v[12:13], v[12:13], v[44:45], v[48:49]
    v_pk_fma_f32 v[14:15], v[14:15], v[46:47], v[50:51]
    s_waitcnt vmcnt(2) lgkmcnt(0)
    v_mfma_f32_16x16x32_bf16 v[32:35], v[52:55], v[70:73], v[8:11]
    v_exp_f32 v44, v28
    v_exp_f32 v45, v29
    v_mfma_f32_4x4x4_16b_bf16 v[40:43], v[116:117], v[74:75], 0
    v_exp_f32 v46, v30
    v_exp_f32 v47, v31
    ds_read2_b32 v[56:57], v21 offset0:8 offset1:9
    v_pk_fma_f32 v[48:49], v[36:37], v[16:17], v[12:13]
    v_pk_fma_f32 v[50:51], v[38:39], v[18:19], v[14:15]
    v_pk_fma_f32 v[16:17], v[16:17], v[44:45], v[16:17]
    v_pk_fma_f32 v[18:19], v[18:19], v[46:47], v[18:19]
    v_pk_fma_f32 v[12:13], v[12:13], v[44:45], v[48:49]
    v_pk_fma_f32 v[14:15], v[14:15], v[46:47], v[50:51]
    s_waitcnt vmcnt(1)
    v_mfma_f32_16x16x32_bf16 v[28:31], v[52:55], v[76:79], v[8:11]
    v_exp_f32 v44, v32
    v_exp_f32 v45, v33
    v_mfma_f32_4x4x4_16b_bf16 v[36:39], v[116:117], v[80:81], 0
    v_exp_f32 v46, v34
    v_exp_f32 v47, v35
    v_pk_fma_f32 v[48:49], v[40:41], v[16:17], v[12:13]
    v_pk_fma_f32 v[50:51], v[42:43], v[18:19], v[14:15]
    v_pk_fma_f32 v[16:17], v[16:17], v[44:45], v[16:17]
    v_pk_fma_f32 v[18:19], v[18:19], v[46:47], v[18:19]
    v_pk_fma_f32 v[12:13], v[12:13], v[44:45], v[48:49]
    v_pk_fma_f32 v[14:15], v[14:15], v[46:47], v[50:51]
    s_waitcnt vmcnt(0) lgkmcnt(0)
    v_mfma_f32_16x16x32_bf16 v[32:35], v[56:59], v[82:85], v[8:11]
    v_exp_f32 v44, v28
    v_exp_f32 v45, v29
    v_mfma_f32_4x4x4_16b_bf16 v[40:43], v[116:117], v[86:87], 0
    v_exp_f32 v46, v30
    v_exp_f32 v47, v31
    v_pk_fma_f32 v[48:49], v[36:37], v[16:17], v[12:13]
    v_pk_fma_f32 v[50:51], v[38:39], v[18:19], v[14:15]
    v_pk_fma_f32 v[16:17], v[16:17], v[44:45], v[16:17]
    v_pk_fma_f32 v[18:19], v[18:19], v[46:47], v[18:19]
    v_pk_fma_f32 v[12:13], v[12:13], v[44:45], v[48:49]
    v_pk_fma_f32 v[14:15], v[14:15], v[46:47], v[50:51]
    v_exp_f32 v44, v32
    v_exp_f32 v45, v33
    v_exp_f32 v46, v34
    v_exp_f32 v47, v35
    v_pk_fma_f32 v[48:49], v[40:41], v[16:17], v[12:13]
    v_pk_fma_f32 v[50:51], v[42:43], v[18:19], v[14:15]
    v_pk_fma_f32 v[16:17], v[16:17], v[44:45], v[16:17]
    v_pk_fma_f32 v[18:19], v[18:19], v[46:47], v[18:19]
    v_pk_fma_f32 v[12:13], v[12:13], v[44:45], v[48:49]
    v_pk_fma_f32 v[14:15], v[14:15], v[46:47], v[50:51]
    s_branch L_loop_done
L_even2:
    s_cmp_lg_u32 s78, 0
    s_cbranch_scc1 L_keep2
    s_setprio 0
L_keep2:
    s_waitcnt vmcnt(3) lgkmcnt(0)
    v_mfma_f32_16x16x32_bf16 v[32:35], v[56:59], v[82:85], v[8:11]
    v_exp_f32 v44, v28
    v_exp_f32 v45, v29
    v_mfma_f32_4x4x4_16b_bf16 v[40:43], v[116:117], v[86:87], 0
    v_exp_f32 v46, v30
    v_exp_f32 v47, v31
    ds_read2_b32 v[52:53], v21 offset0:6 offset1:7
    v_pk_fma_f32 v[48:49], v[36:37], v[16:17], v[12:13]
    v_pk_fma_f32 v[50:51], v[38:39], v[18:19], v[14:15]
    v_pk_fma_f32 v[16:17], v[16:17], v[44:45], v[16:17]
    v_pk_fma_f32 v[18:19], v[18:19], v[46:47], v[18:19]
    v_pk_fma_f32 v[12:13], v[12:13], v[44:45], v[48:49]
    v_pk_fma_f32 v[14:15], v[14:15], v[46:47], v[50:51]
    s_waitcnt vmcnt(2)
    v_mfma_f32_16x16x32_bf16 v[28:31], v[56:59], v[64:67], v[8:11]
    v_exp_f32 v44, v32
    v_exp_f32 v45, v33
    v_mfma_f32_4x4x4_16b_bf16 v[36:39], v[116:117], v[68:69], 0
    v_exp_f32 v46, v34
    v_exp_f32 v47, v35
    v_pk_fma_f32 v[48:49], v[40:41], v[16:17], v[12:13]
    v_pk_fma_f32 v[50:51], v[42:43], v[18:19], v[14:15]
    v_pk_fma_f32 v[16:17], v[16:17], v[44:45], v[16:17]
    v_pk_fma_f32 v[18:19], v[18:19], v[46:47], v[18:19]
    v_pk_fma_f32 v[12:13], v[12:13], v[44:45], v[48:49]
    v_pk_fma_f32 v[14:15], v[14:15], v[46:47], v[50:51]
    s_waitcnt vmcnt(1) lgkmcnt(0)
    v_mfma_f32_16x16x32_bf16 v[32:35], v[52:55], v[70:73], v[8:11]
    v_exp_f32 v44, v28
    v_exp_f32 v45, v29
    v_mfma_f32_4x4x4_16b_bf16 v[40:43], v[116:117], v[74:75], 0
    v_exp_f32 v46, v30
    v_exp_f32 v47, v31
    v_pk_fma_f32 v[48:49], v[36:37], v[16:17], v[12:13]
    v_pk_fma_f32 v[50:51], v[38:39], v[18:19], v[14:15]
    v_pk_fma_f32 v[16:17], v[16:17], v[44:45], v[16:17]
    v_pk_fma_f32 v[18:19], v[18:19], v[46:47], v[18:19]
    v_pk_fma_f32 v[12:13], v[12:13], v[44:45], v[48:49]
    v_pk_fma_f32 v[14:15], v[14:15], v[46:47], v[50:51]
    s_waitcnt vmcnt(0)
    v_mfma_f32_16x16x32_bf16 v[28:31], v[52:55], v[76:79], v[8:11]
    v_exp_f32 v44, v32
    v_exp_f32 v45, v33
    v_mfma_f32_4x4x4_16b_bf16 v[36:39], v[116:117], v[80:81], 0
    v_exp_f32 v46, v34
    v_exp_f32 v47, v35
    v_pk_fma_f32 v[48:49], v[40:41], v[16:17], v[12:13]
    v_pk_fma_f32 v[50:51], v[42:43], v[18:19], v[14:15]
    v_pk_fma_f32 v[16:17], v[16:17], v[44:45], v[16:17]
    v_pk_fma_f32 v[18:19], v[18:19], v[46:47], v[18:19]
    v_pk_fma_f32 v[12:13], v[12:13], v[44:45], v[48:49]
    v_pk_fma_f32 v[14:15], v[14:15], v[46:47], v[50:51]
    v_exp_f32 v44, v28
    v_exp_f32 v45, v29
    v_exp_f32 v46, v30
    v_exp_f32 v47, v31
    v_pk_fma_f32 v[48:49], v[36:37], v[16:17], v[12:13]
    v_pk_fma_f32 v[50:51], v[38:39], v[18:19], v[14:15]
    v_pk_fma_f32 v[16:17], v[16:17], v[44:45], v[16:17]
    v_pk_fma_f32 v[18:19], v[18:19], v[46:47], v[18:19]
    v_pk_fma_f32 v[12:13], v[12:13], v[44:45], v[48:49]
    v_pk_fma_f32 v[14:15], v[14:15], v[46:47], v[50:51]
L_loop_done:
    s_cmp_eq_u32 s78, 0
    s_cbranch_scc1 L_nodb2
    buffer_load_dwordx4 v[66:69], v[88:89], s[24:27], s70 idxen offen sc1
    buffer_load_dwordx4 v[72:75], v[90:91], s[24:27], s70 idxen offen sc1
    buffer_load_dwordx4 v[78:81], v[92:93], s[24:27], s70 idxen offen sc1
    buffer_load_dwordx4 v[84:87], v[94:95], s[24:27], s70 idxen offen sc1
    s_mov_b32 s68, 1
L_nodb2:
    v_rcp_f32 v44, v16
    v_rcp_f32 v45, v17
    v_rcp_f32 v46, v18
    v_rcp_f32 v47, v19
    v_pk_add_f32 v[16:17], v[16:17], v[18:19]
    v_pk_mul_f32 v[12:13], v[12:13], v[44:45]
    v_pk_mul_f32 v[14:15], v[14:15], v[46:47]
    v_pk_fma_f32 v[16:17], v[12:13], 0, v[16:17] op_sel_hi:[1,0,1]
    v_pk_fma_f32 v[16:17], v[14:15], 0, v[16:17] op_sel_hi:[1,0,1]
    v_add_f32 v2, v16, v17
    v_cmp_ngt_f32 vcc, 0x7b800000, v2
    s_cbranch_vccnz L_safe
L_silu:
    v_pk_mul_f32 v[28:29], v[12:13], s[40:41]
    v_pk_mul_f32 v[30:31], v[14:15], s[40:41]
    v_exp_f32 v44, v28
    v_exp_f32 v45, v29
    v_exp_f32 v46, v30
    v_exp_f32 v47, v31
    v_pk_add_f32 v[44:45], v[44:45], 1.0 op_sel_hi:[1,0]
    v_pk_add_f32 v[46:47], v[46:47], 1.0 op_sel_hi:[1,0]
    v_rcp_f32 v44, v44
    v_rcp_f32 v45, v45
    v_rcp_f32 v46, v46
    v_rcp_f32 v47, v47
    v_pk_mul_f32 v[12:13], v[12:13], v[44:45]
    v_pk_mul_f32 v[14:15], v[14:15], v[46:47]
    v_cvt_pk_bf16_f32 v48, v12, v13
    v_cvt_pk_bf16_f32 v49, v14, v15
    s_cmp_eq_u32 s78, 0
    buffer_store_dwordx2 v[48:49], v22, s[28:31], s57 offen sc1
    s_cbranch_scc1 L_fin
    s_add_u32 s54, s54, 4
    s_mov_b32 s78, 0
    v_add_u32 v110, 64, v110
    v_add_u32 v111, 64, v111
    v_mov_b32 v16, 1.0
    v_mov_b32 v17, 1.0
    v_mov_b64 v[18:19], v[16:17]
    v_mov_b32 v23, v100
    v_mov_b32 v21, v101
    v_mov_b32 v20, v102
    v_readfirstlane_b32 s55, v100
    s_cmp_lg_u32 s68, 0
    s_cbranch_scc1 L_go2
    v_mov_b32 v67, v119
    v_mov_b32 v73, v119
    v_mov_b32 v79, v119
    v_mov_b32 v85, v119
    v_mov_b32 v16, 1.0
    v_mov_b32 v17, 1.0
    v_mov_b64 v[18:19], v[16:17]
    s_branch L_batch
L_fin:
L_end:
    s_endpgm
L_lower:
    s_sub_i32 s44, 4, s78
    s_cmp_eq_i32 s44, s79
    s_cselect_b32 s79, -100, s44
    s_setprio 2
    s_cbranch_scc0 L_lowered
    s_setprio 1
    s_branch L_lowered
.p2align 6
L_probe:
    s_waitcnt lgkmcnt(0)
    s_load_dwordx2 s[66:67], s[0:1], 64
    s_waitcnt lgkmcnt(0)
    s_setprio 3
    s_load_dword s46, s[20:21], s48 glc
    s_load_dword s47, s[20:21], s48 offset:0x2000 glc
    s_mov_b32 s44, 0
    s_waitcnt lgkmcnt(1)
L_gap:
    s_add_u32 s44, s44, 1
    s_getreg_b32 s45, hwreg(HW_REG_IB_STS, 8, 4)
    s_mul_i32 s49, s45, 3
    s_cmp_gt_u32 s49, s44
    s_cbranch_scc1 L_gap
L_fake:
    s_cmp_eq_u32 s45, 0
    s_cselect_b32 s44, 3, 2
    s_mov_b32 s62, s44
    s_atomic_add s62, s[66:67], 0 glc
    s_mov_b32 s63, s44
    s_atomic_add s63, s[66:67], 64 glc
    s_mov_b32 s64, s44
    s_atomic_add s64, s[66:67], 128 glc
    s_mov_b32 s65, s44
    s_atomic_add s65, s[66:67], 192 glc
    s_setprio 2
    s_branch L_probed
L_selwait:
    v_mov_b32 v2, 0
    ds_read_b32 v2, v2 offset:1284
    s_waitcnt lgkmcnt(0)
    v_cmp_eq_u32 vcc, 0, v2
    s_cbranch_vccnz L_selwait
    s_branch L_selgot
L_slotretry:
    buffer_load_dwordx4 v[4:7], v113, s[20:23], s74 offen sc1
    s_add_u32 s59, s59, 1
    s_cmp_lt_u32 s59, 2097152
    s_cbranch_scc1 L_slotchk
    s_waitcnt vmcnt(0)
    v_mov_b32 v7, 0xfefefefe
    s_mov_b64 vcc, 0
    s_branch L_slotok
L_code_end:
L_selslow:
    global_load_dword v28, v15, s[66:67] sc1
    s_add_u32 s45, s45, 1
    s_waitcnt vmcnt(0) lgkmcnt(0)
    v_readfirstlane_b32 s44, v28
    s_cmp_ge_u32 s45, 2097152
    s_cbranch_scc1 L_selok
    s_cmp_eq_u32 s44, 0
    s_cbranch_scc1 L_selslow
    s_branch L_selok
L_ovf:
    v_sub_u32 v14, v14, v15
    v_max_u32 v14, v14, v15
    v_cmp_lt_u32 vcc, 100608, v14
    v_mov_b32 v11, 0xfefefe
    v_mov_b32 v12, 0
    s_mov_b64 exec, vcc
    ds_write_b32 v12, v11 offset:1280
    s_mov_b64 exec, -1
    v_lshl_or_b32 v11, v26, 24, v11
    s_branch L_noovf
L_mark:
    s_ff1_i32_b64 s44, s[66:67]
    s_and_b32 s45, s44, 48
    s_bfm_b64 vcc, 16, s45
    s_andn2_b64 s[66:67], s[66:67], vcc
    s_lshr_b32 s44, s44, 4
    s_lshl2_add_u32 s44, s32, s44
    s_mul_i32 s44, s44, 2500
    s_add_u32 s45, s44, 2500
L_mark_loop:
    v_add_u32 v28, s44, v1
    v_lshlrev_b32 v29, 2, v28
    v_lshlrev_b32 v30, 1, v28
    v_cmp_gt_u32 vcc, s45, v28
    s_mov_b64 exec, vcc
    global_load_dword v31, v29, s[10:11]
    global_load_dword v32, v29, s[8:9]
    global_load_ushort v33, v30, s[6:7]
    s_waitcnt vmcnt(0)
    v_and_b32 v29, 127, v31
    v_cmp_eq_u32 vcc, s35, v29
    s_and_b64 exec, vcc, vcc
    s_cbranch_scc0 L_mark_skip
    v_lshrrev_b32 v31, 7, v31
    v_xor_b32 v30, s35, v32
    v_bfe_u32 v30, v30, 6, 1
    v_lshlrev_b32 v29, 3, v31
    v_lshl_add_u32 v29, v30, 2, v29
    v_lshl_add_u32 v30, v30, 3, -4
    ds_add_rtn_u32 v29, v29, v30 offset:64
    v_and_b32 v34, 0xffffffe0, v32
    v_add_u32 v32, v32, v34
    v_and_b32 v34, 0xffffe000, v32
    v_add_u32 v32, v32, v34
    v_lshl_or_b32 v32, v33, 16, v32
    v_mul_u32_u24 v31, 388, v31
    v_add_u32 v31, 100608, v31
    s_waitcnt lgkmcnt(0)
    v_sub_u32 v31, v29, v31
    v_cmp_le_u32 vcc, 384, v31
    s_cbranch_vccnz L_mark_full
    ds_write_b32 v29, v32
L_mark_skip:
    s_mov_b64 exec, -1
    s_add_u32 s44, s44, 64
    s_cmp_lt_u32 s44, s45
    s_cbranch_scc1 L_mark_loop
    s_cmp_lg_u64 s[66:67], 0
    s_cbranch_scc1 L_mark
    s_branch L_nomark
L_mark_full:
    ds_write_b32 v14, v27 offset:1280
    s_mov_b64 exec, -1
    s_branch L_nomark
L_safe:
    v_and_b32 v2, 0x7f, v23
    v_mul_u32_u24 v2, 528, v2
    v_add_u32 v2, v2, v119
    ds_read_b128 v[12:15], v2 offset:35072
    ds_read_b128 v[4:7], v119 offset:1536
    v_lshrrev_b32 v20, 16, v23
    v_lshlrev_b32 v20, 2, v20
    s_add_u32 s44, s55, 5
L_safe_loop:
    ds_read_b32 v2, v20 offset:4
    v_add_u32 v20, 4, v20
    s_waitcnt lgkmcnt(0)
    v_and_b32 v118, 0xffff, v2
    v_and_b32 v24, 0xffff0000, v2
    buffer_load_dwordx4 v[96:99], v[118:119], s[24:27], s70 idxen offen sc1
    v_pk_fma_f32 v[28:29], v[24:25], v[4:5], v[8:9] op_sel_hi:[0,1,1]
    v_pk_fma_f32 v[30:31], v[24:25], v[6:7], v[10:11] op_sel_hi:[0,1,1]
    s_waitcnt vmcnt(0)
    v_lshlrev_b32 v48, 16, v96
    v_and_b32 v49, 0xffff0000, v96
    v_lshlrev_b32 v50, 16, v97
    v_and_b32 v51, 0xffff0000, v97
    v_pk_add_f32 v[28:29], v[28:29], v[48:49]
    v_pk_add_f32 v[30:31], v[30:31], v[50:51]
    v_lshlrev_b32 v48, 16, v98
    v_and_b32 v49, 0xffff0000, v98
    v_lshlrev_b32 v50, 16, v99
    v_and_b32 v51, 0xffff0000, v99
    v_exp_f32 v44, v28
    v_exp_f32 v45, v29
    v_exp_f32 v46, v30
    v_exp_f32 v47, v31
    v_pk_add_f32 v[44:45], v[44:45], 1.0 op_sel_hi:[1,0]
    v_pk_add_f32 v[46:47], v[46:47], 1.0 op_sel_hi:[1,0]
    v_rcp_f32 v44, v44
    v_rcp_f32 v45, v45
    v_rcp_f32 v46, v46
    v_rcp_f32 v47, v47
    v_pk_fma_f32 v[12:13], v[48:49], v[44:45], v[12:13]
    v_pk_fma_f32 v[14:15], v[50:51], v[46:47], v[14:15]
    s_sub_u32 s44, s44, 1
    s_cmp_lg_u32 s44, 0
    s_cbranch_scc1 L_safe_loop
    s_branch L_silu
L_scan:
    ds_read_b128 v[4:7], v119 offset:1536
    s_waitcnt lgkmcnt(0)
    v_and_b32 v108, 0x7f, v23
    v_lshlrev_b32 v108, 7, v108
    v_add_u32 v108, s35, v108
    v_lshlrev_b32 v104, 2, v1
    v_lshlrev_b32 v105, 1, v1
    s_mov_b32 s44, 0
L_scan_outer:
    global_load_dword v106, v104, s[10:11]
    global_load_dword v107, v104, s[8:9]
    global_load_ushort v109, v105, s[6:7]
    v_add_u32 v104, 256, v104
    v_add_u32 v105, 128, v105
    s_waitcnt vmcnt(0)
    v_and_b32 v2, 127, v106
    v_cmp_eq_u32 s[60:61], s35, v2
    v_lshlrev_b32 v109, 16, v109
    v_and_b32 v2, 0xffffffe0, v107
    v_add_u32 v107, v107, v2
    v_and_b32 v2, 0xffffe000, v107
    v_add_u32 v107, v107, v2
L_scan_inner:
    s_cmp_eq_u64 s[60:61], 0
    s_cbranch_scc1 L_scan_next
    s_ff1_i32_b64 s45, s[60:61]
    s_bitset0_b64 s[60:61], s45
    v_readlane_b32 s46, v106, s45
    v_readlane_b32 s47, v107, s45
    v_readlane_b32 s48, v109, s45
    s_nop 1
    v_cmp_eq_u32 vcc, s46, v108
    s_and_b64 exec, vcc, vcc
    s_cbranch_scc0 L_scan_skip
    v_mov_b32 v118, s47
    v_mov_b32 v24, s48
    buffer_load_dwordx4 v[96:99], v[118:119], s[24:27], s70 idxen offen sc1
    v_pk_fma_f32 v[28:29], v[24:25], v[4:5], v[8:9] op_sel_hi:[0,1,1]
    v_pk_fma_f32 v[30:31], v[24:25], v[6:7], v[10:11] op_sel_hi:[0,1,1]
    s_waitcnt vmcnt(0)
    v_lshlrev_b32 v48, 16, v96
    v_and_b32 v49, 0xffff0000, v96
    v_lshlrev_b32 v50, 16, v97
    v_and_b32 v51, 0xffff0000, v97
    v_pk_add_f32 v[28:29], v[28:29], v[48:49]
    v_pk_add_f32 v[30:31], v[30:31], v[50:51]
    v_lshlrev_b32 v48, 16, v98
    v_and_b32 v49, 0xffff0000, v98
    v_lshlrev_b32 v50, 16, v99
    v_and_b32 v51, 0xffff0000, v99
    v_exp_f32 v44, v28
    v_exp_f32 v45, v29
    v_exp_f32 v46, v30
    v_exp_f32 v47, v31
    v_pk_add_f32 v[44:45], v[44:45], 1.0 op_sel_hi:[1,0]
    v_pk_add_f32 v[46:47], v[46:47], 1.0 op_sel_hi:[1,0]
    v_rcp_f32 v44, v44
    v_rcp_f32 v45, v45
    v_rcp_f32 v46, v46
    v_rcp_f32 v47, v47
    v_pk_fma_f32 v[12:13], v[48:49], v[44:45], v[12:13]
    v_pk_fma_f32 v[14:15], v[50:51], v[46:47], v[14:15]
L_scan_skip:
    s_mov_b64 exec, -1
    s_branch L_scan_inner
L_scan_next:
    s_add_u32 s44, s44, 1
    s_cmp_lt_u32 s44, 2500
    s_cbranch_scc1 L_scan_outer
    s_branch L_silu
.section .rodata,"a"
.p2align 6
.amdhsa_kernel gather_scatter__edge_featured_mpnn_egc__graph_kernel
.amdhsa_next_free_vgpr 128
.amdhsa_next_free_sgpr 80
.amdhsa_accum_offset 128
.amdhsa_group_segment_fixed_size 0
.amdhsa_kernarg_size 80
.amdhsa_user_sgpr_count 2
.amdhsa_user_sgpr_kernarg_segment_ptr 1
.amdhsa_system_sgpr_workgroup_id_x 1
.end_amdhsa_kernel
```
